```python
import torch

def _softmax(x, axis=-1):
    return torch.softmax(x, dim=axis)

def _gelu(x):
    return torch.nn.functional.gelu(x, approximate='tanh')

def _silu(x):
    return torch.nn.functional.silu(x)

def _sigmoid(x):
    return torch.sigmoid(x)

def _layernorm(x, axis=-1, eps=1e-05):
    m = x.mean(dim=axis, keepdim=True)
    v = x.var(dim=axis, keepdim=True, unbiased=False)
    return (x - m) / torch.sqrt(v + eps)

def _scatter_add(tgt, idx, src, axis=0):
    return tgt.clone().index_add_(axis, idx, src)

def _segment_sum(src, seg, n):
    out = torch.zeros((n,) + src.shape[1:], dtype=src.dtype)
    return out.index_add_(0, seg, src)

def _pad(x, pw):
    flat = tuple((v for pair in reversed(pw) for v in pair))
    return torch.nn.functional.pad(x, flat)
kernel_name = 'standalone__tensor_product_equiv_tfn__graph'

def setup_inputs():

    _w = lambda a: (lambda t: t.to(torch.bfloat16) if t.is_floating_point() else t)(torch.as_tensor(a))
    N, deg, C, L, DE = (10000, 32, 128, 1, 4)
    E = N * deg
    M = (L + 1) ** 2
    src = (lambda lo, hi, *s: torch.randint(lo, hi, s))(0, N, E).to(torch.int64)
    dst = (lambda lo, hi, *s: torch.randint(lo, hi, s))(0, N, E).to(torch.int64)
    r = (lambda *s: torch.randn(*s, dtype=torch.bfloat16) * 0.05)(E, 3)
    r = r / (torch.linalg.norm(r, dim=-1, keepdim=True) + 1e-09)
    rx, ry, rz = (r[:, 0].clone(), r[:, 1].clone(), r[:, 2].clone())
    Ys = [torch.ones((E, 1), dtype=float)]
    if L >= 1:
        Ys.append(r.to(float))
    if L >= 2:
        Ys.append(torch.stack([2 * rx * ry, 2 * ry * rz, (3 * rz * rz - 1.0) / (lambda _x: torch.sqrt(torch.as_tensor(_x)))(3.0), 2 * rx * rz, rx * rx - ry * ry], dim=-1).to(float))
    for _l in range(3, L + 1):
        Ys.append(((lambda *s: torch.randn(*s, dtype=torch.bfloat16) * 0.05)(E, 2 * _l + 1) * 0.3).to(float))
    Y = torch.cat(Ys, dim=-1)
    cg = torch.zeros((M, M, M), dtype=float)
    off = [_l * _l for _l in range(L + 2)]
    for l1 in range(L + 1):
        for l2 in range(L + 1):
            for l3 in range(abs(l1 - l2), min(L, l1 + l2) + 1):
                d1, d2, d3 = (2 * l1 + 1, 2 * l2 + 1, 2 * l3 + 1)
                cg[off[l1]:off[l1 + 1], off[l2]:off[l2 + 1], off[l3]:off[l3 + 1]] = (lambda *s: torch.randn(*s, dtype=torch.bfloat16) * 0.05)(d1, d2, d3) / (lambda _x: torch.sqrt(torch.as_tensor(_x)))(float(d1 * d2))
    return {'x': _w((lambda *s: torch.randn(*s, dtype=torch.bfloat16) * 0.05)(N, C, M) * 0.2), 'src': _w(src), 'dst': _w(dst), 'Y': _w(Y), 'edge_feat': _w((lambda *s: torch.randn(*s, dtype=torch.bfloat16) * 0.05)(E, DE)), 'w_rad': _w((lambda *s: torch.randn(*s, dtype=torch.bfloat16) * 0.05)(DE, C) * (1.0 / max(1.0, DE) ** 0.5)), 'cg': _w(cg), 'w_mix': _w((lambda *s: torch.randn(*s, dtype=torch.bfloat16) * 0.05)(C, C) * (1.0 / max(1.0, C) ** 0.5))}

def reference(x, src, dst, Y, edge_feat, w_rad, cg, w_mix):
    N, C, M = (x.shape[0], x.shape[1], x.shape[2])
    R = _silu(edge_feat @ w_rad)
    xs = x[src]
    tp = torch.einsum('eci,ef,ifo->eco', xs, Y, cg)
    msg = R[:, :, None] * tp
    agg = _segment_sum(msg.reshape(-1, C * M), dst, N).reshape(N, C, M)
    return torch.einsum('ncm,cd->ndm', agg, w_mix)
```

```asm
; @launch grid=(250,1,1) block=(1024,1,1) lds=133760
.amdgcn_target "amdgcn-amd-amdhsa--gfx950"
.text
.globl standalone__tensor_product_equiv_tfn__graph_kernel
.p2align 8
.type standalone__tensor_product_equiv_tfn__graph_kernel,@function
standalone__tensor_product_equiv_tfn__graph_kernel:
    s_cmp_ge_u32 s2, 250
    s_cbranch_scc1 K2_END
    s_load_dwordx4 s[4:7], s[0:1], 8
    s_load_dwordx4 s[8:11], s[0:1], 24
    s_load_dwordx2 s[12:13], s[0:1], 80
    s_load_dwordx2 s[26:27], s[0:1], 40
    s_load_dwordx4 s[28:31], s[0:1], 48
    s_load_dwordx2 s[32:33], s[0:1], 0
    s_load_dwordx2 s[72:73], s[0:1], 72
    v_lshrrev_b32 v6, 6, v0
    v_and_b32 v7, 63, v0
    v_readfirstlane_b32 s25, v6
    s_nop 3
    s_cmp_ge_u32 s25, 5
    s_cbranch_scc1 F_OTHER
    s_mul_i32 s14, s2, 5120
    v_lshlrev_b32 v1, 4, v0
    v_add_u32 v1, s14, v1
    v_lshlrev_b32 v2, 1, v1
    v_lshlrev_b32 v3, 2, v0
    v_mov_b32 v4, 0
    v_mov_b32 v5, 1
    v_cmp_gt_u32 vcc, 0x100, v0
    s_and_saveexec_b64 s[16:17], vcc
    s_cbranch_execz F_NOZ
    ds_write_b32 v3, v4
F_NOZ:
    s_mov_b64 exec, s[16:17]
    s_waitcnt lgkmcnt(0)
    global_load_dwordx4 v[8:11], v1, s[6:7]
    global_load_dwordx4 v[12:15], v1, s[4:5]
    global_load_dwordx4 v[16:19], v2, s[8:9]
    global_load_dwordx4 v[20:23], v2, s[8:9] offset:16
    global_load_dwordx4 v[24:27], v2, s[10:11]
    global_load_dwordx4 v[28:31], v2, s[10:11] offset:16
    s_mul_i32 s15, s2, 20608
    s_mul_i32 s14, s2, 5152
    s_add_u32 s18, s12, 0
    s_addc_u32 s19, s13, 0
    s_add_u32 s18, s18, s14
    s_addc_u32 s19, s19, 0
    s_add_u32 s20, s12, 1310720
    s_addc_u32 s21, s13, 0
    s_add_u32 s20, s20, s15
    s_addc_u32 s21, s21, 0
    s_lshl_b32 s15, s2, 10
    s_add_u32 s22, s12, 6488064
    s_addc_u32 s23, s13, 0
    s_add_u32 s22, s22, s15
    s_addc_u32 s23, s23, 0
    s_movk_i32 s24, -40
    s_barrier
    s_waitcnt vmcnt(4)
    v_mul_u32_u24 v44, 0xcccd, v8
    v_lshrrev_b32 v44, 21, v44
    v_mad_i32_i24 v45, v44, s24, v8
    v_lshlrev_b32 v36, 2, v44
    ds_add_rtn_u32 v40, v36, v5
    v_mul_u32_u24 v46, 0xcd, v45
    v_lshrrev_b32 v46, 10, v46
    v_mad_i32_i24 v47, v46, -5, v45
    v_mul_u32_u24 v48, 209, v12
    v_lshrrev_b32 v48, 16, v48
    v_lshl_add_u32 v48, v46, 5, v48
    v_lshl_or_b32 v32, v47, 14, v12
    v_lshl_or_b32 v32, v48, 17, v32
    v_mul_u32_u24 v44, 0xcccd, v9
    v_lshrrev_b32 v44, 21, v44
    v_mad_i32_i24 v45, v44, s24, v9
    v_lshlrev_b32 v37, 2, v44
    ds_add_rtn_u32 v41, v37, v5
    v_mul_u32_u24 v46, 0xcd, v45
    v_lshrrev_b32 v46, 10, v46
    v_mad_i32_i24 v47, v46, -5, v45
    v_mul_u32_u24 v48, 209, v13
    v_lshrrev_b32 v48, 16, v48
    v_lshl_add_u32 v48, v46, 5, v48
    v_lshl_or_b32 v33, v47, 14, v13
    v_lshl_or_b32 v33, v48, 17, v33
    v_mul_u32_u24 v44, 0xcccd, v10
    v_lshrrev_b32 v44, 21, v44
    v_mad_i32_i24 v45, v44, s24, v10
    v_lshlrev_b32 v38, 2, v44
    ds_add_rtn_u32 v42, v38, v5
    v_mul_u32_u24 v46, 0xcd, v45
    v_lshrrev_b32 v46, 10, v46
    v_mad_i32_i24 v47, v46, -5, v45
    v_mul_u32_u24 v48, 209, v14
    v_lshrrev_b32 v48, 16, v48
    v_lshl_add_u32 v48, v46, 5, v48
    v_lshl_or_b32 v34, v47, 14, v14
    v_lshl_or_b32 v34, v48, 17, v34
    v_mul_u32_u24 v44, 0xcccd, v11
    v_lshrrev_b32 v44, 21, v44
    v_mad_i32_i24 v45, v44, s24, v11
    v_lshlrev_b32 v39, 2, v44
    ds_add_rtn_u32 v43, v39, v5
    v_mul_u32_u24 v46, 0xcd, v45
    v_lshrrev_b32 v46, 10, v46
    v_mad_i32_i24 v47, v46, -5, v45
    v_mul_u32_u24 v48, 209, v15
    v_lshrrev_b32 v48, 16, v48
    v_lshl_add_u32 v48, v46, 5, v48
    v_lshl_or_b32 v35, v47, 14, v15
    v_lshl_or_b32 v35, v48, 17, v35
    s_waitcnt vmcnt(0)
    v_swap_b32 v18, v24
    v_swap_b32 v19, v25
    v_swap_b32 v22, v28
    v_swap_b32 v23, v29
    v_lshlrev_b32 v50, 4, v7
    s_waitcnt lgkmcnt(0)
    s_barrier
    ds_read_b128 v[52:55], v50
    s_waitcnt lgkmcnt(0)
    v_add_u32 v56, v52, v53
    v_add_u32 v57, v56, v54
    v_add_u32 v58, v57, v55
    v_mov_b32 v59, v58
    s_nop 1
    v_add_u32_dpp v59, v59, v59 row_shr:1 row_mask:0xf bank_mask:0xf bound_ctrl:1
    s_nop 1
    v_add_u32_dpp v59, v59, v59 row_shr:2 row_mask:0xf bank_mask:0xf bound_ctrl:1
    s_nop 1
    v_add_u32_dpp v59, v59, v59 row_shr:4 row_mask:0xf bank_mask:0xf bound_ctrl:1
    s_nop 1
    v_add_u32_dpp v59, v59, v59 row_shr:8 row_mask:0xf bank_mask:0xf bound_ctrl:1
    s_nop 1
    v_add_u32_dpp v59, v59, v59 row_bcast:15 row_mask:0xa bank_mask:0xf
    s_nop 1
    v_add_u32_dpp v59, v59, v59 row_bcast:31 row_mask:0xc bank_mask:0xf
    v_sub_u32 v60, v59, v58
    v_add_u32 v61, v60, v52
    v_add_u32 v62, v60, v56
    v_add_u32 v63, v60, v57
    ds_write_b128 v50, v[60:63] offset:1024
    s_cmp_lg_u32 s25, 0
    s_cbranch_scc1 F_CS
    v_lshl_or_b32 v64, v52, 16, v60
    v_lshl_or_b32 v65, v53, 16, v61
    v_lshl_or_b32 v66, v54, 16, v62
    v_lshl_or_b32 v67, v55, 16, v63
    global_store_dwordx4 v50, v[64:67], s[22:23] sc1
F_CS:
    s_waitcnt lgkmcnt(0)
    ds_read_b32 v44, v36 offset:1024
    ds_read_b32 v45, v37 offset:1024
    ds_read_b32 v46, v38 offset:1024
    ds_read_b32 v47, v39 offset:1024
    s_waitcnt lgkmcnt(3)
    v_add_u32 v44, v44, v40
    v_lshlrev_b32 v48, 2, v44
    v_lshlrev_b32 v49, 4, v44
    ds_write_b128 v49, v[16:19] offset:7168
    ds_write_b32 v48, v32 offset:2048
    s_waitcnt lgkmcnt(4)
    v_add_u32 v45, v45, v41
    v_lshlrev_b32 v48, 2, v45
    v_lshlrev_b32 v49, 4, v45
    ds_write_b128 v49, v[24:27] offset:7168
    ds_write_b32 v48, v33 offset:2048
    s_waitcnt lgkmcnt(5)
    v_add_u32 v46, v46, v42
    v_lshlrev_b32 v48, 2, v46
    v_lshlrev_b32 v49, 4, v46
    ds_write_b128 v49, v[20:23] offset:7168
    ds_write_b32 v48, v34 offset:2048
    s_waitcnt lgkmcnt(6)
    v_add_u32 v47, v47, v43
    v_lshlrev_b32 v48, 2, v47
    v_lshlrev_b32 v49, 4, v47
    ds_write_b128 v49, v[28:31] offset:7168
    ds_write_b32 v48, v35 offset:2048
    v_lshlrev_b32 v50, 4, v0
    s_waitcnt lgkmcnt(0)
    s_barrier
    ds_read_b128 v[8:11], v50 offset:2048
    ds_read_b128 v[12:15], v50 offset:7168
    ds_read_b128 v[16:19], v50 offset:12288
    ds_read_b128 v[20:23], v50 offset:17408
    ds_read_b128 v[24:27], v50 offset:22528
    v_add_u32 v51, 5120, v50
    v_add_u32 v52, 10240, v50
    v_add_u32 v53, 15360, v50
    s_waitcnt lgkmcnt(4)
    global_store_dwordx4 v50, v[8:11], s[18:19] sc1
    s_waitcnt lgkmcnt(3)
    global_store_dwordx4 v50, v[12:15], s[20:21] sc1
    s_waitcnt lgkmcnt(2)
    global_store_dwordx4 v51, v[16:19], s[20:21] sc1
    s_waitcnt lgkmcnt(1)
    global_store_dwordx4 v52, v[20:23], s[20:21] sc1
    s_waitcnt lgkmcnt(0)
    global_store_dwordx4 v53, v[24:27], s[20:21] sc1
    s_cmp_lg_u32 s25, 0
    s_cbranch_scc1 F_JOIN
    v_mov_b32 v66, 0
    global_load_dword v67, v66, s[72:73] sc1
    s_branch F_JOIN
F_OTHER:
    s_waitcnt lgkmcnt(0)
    v_lshrrev_b32 v6, 6, v0
    s_cmp_ge_u32 s2, 8
    s_cbranch_scc1 F_CPX
    v_cmp_eq_u32 vcc, 14, v6
    s_cbranch_vccz F_CPX
    s_getpc_b64 s[38:39]
F_PC:
    s_sub_u32 s38, s38, F_PC-standalone__tensor_product_equiv_tfn__graph_kernel
    s_subb_u32 s39, s39, 0
    v_and_b32 v1, 63, v0
    v_lshlrev_b32 v1, 7, v1
    v_add_u32 v2, 0, v1
    v_cmp_gt_u32 vcc, K2_CODE_END-standalone__tensor_product_equiv_tfn__graph_kernel, v2
    s_and_saveexec_b64 s[16:17], vcc
    s_cbranch_execz F_CPS0
    global_load_dword v124, v2, s[38:39]
F_CPS0:
    s_mov_b64 exec, s[16:17]
    v_add_u32 v2, 8192, v1
    v_cmp_gt_u32 vcc, K2_CODE_END-standalone__tensor_product_equiv_tfn__graph_kernel, v2
    s_and_saveexec_b64 s[16:17], vcc
    s_cbranch_execz F_CPS1
    global_load_dword v125, v2, s[38:39]
F_CPS1:
    s_mov_b64 exec, s[16:17]
F_CPX:
    s_add_u32 s18, s12, 6815744
    s_addc_u32 s19, s13, 0
    s_cmp_lg_u32 s2, 0
    s_cbranch_scc1 F_NN
    s_cmp_lg_u32 s25, 15
    s_cbranch_scc1 F_NN
    s_memrealtime s[38:39]
    s_waitcnt lgkmcnt(0)
    s_or_b32 s38, s38, 1
    v_mov_b32 v1, 0
    v_mov_b32 v2, s38
    v_cmp_eq_u32 vcc, 0, v7
    s_and_saveexec_b64 s[16:17], vcc
    global_store_dword v1, v2, s[72:73] sc1
    s_mov_b64 exec, s[16:17]
F_NN:
    s_cmp_lg_u32 s25, 13
    s_cbranch_scc1 F_TLX
    s_load_dwordx2 s[38:39], s[0:1], 64
    s_mul_i32 s14, s2, 20608
    s_add_u32 s14, s14, 1331200
    s_min_u32 s14, s14, 6462592
    v_mov_b32 v1, s14
    v_mov_b32 v2, 1306624
    v_cmp_eq_u32 vcc, 1, v7
    s_nop 1
    v_cndmask_b32 v1, v1, v2, vcc
    v_mov_b32 v2, 8126464
    v_cmp_eq_u32 vcc, 2, v7
    s_nop 1
    v_cndmask_b32 v1, v1, v2, vcc
    v_mov_b32 v2, 2361600
    v_cmp_eq_u32 vcc, 3, v7
    s_nop 1
    v_cndmask_b32 v1, v1, v2, vcc
    v_mov_b32 v2, 4422400
    v_cmp_eq_u32 vcc, 4, v7
    s_nop 1
    v_cndmask_b32 v1, v1, v2, vcc
    v_mov_b32 v2, 6277120
    v_cmp_eq_u32 vcc, 5, v7
    s_nop 1
    v_cndmask_b32 v1, v1, v2, vcc
    v_cmp_gt_u32 vcc, 6, v7
    s_and_saveexec_b64 s[16:17], vcc
    global_load_dword v120, v1, s[12:13]
    s_mov_b64 exec, s[16:17]
    v_mov_b32 v5, 0
    v_mov_b32 v6, 192
    v_cmp_eq_u32 vcc, 0, v7
    s_and_saveexec_b64 s[16:17], vcc
    global_load_dword v123, v5, s[26:27]
    global_load_dword v124, v5, s[28:29]
    global_load_dword v125, v6, s[72:73]
    s_mov_b64 exec, s[16:17]
    v_lshlrev_b32 v3, 21, v7
    v_cmp_gt_u32 vcc, 5, v7
    s_and_saveexec_b64 s[16:17], vcc
    global_load_dword v121, v3, s[32:33]
    s_mov_b64 exec, s[16:17]
    s_and_b32 s14, s2, 7
    s_mul_i32 s15, s14, 31
    s_min_u32 s14, s14, 2
    s_add_u32 s15, s15, s14
    s_lshr_b32 s14, s2, 3
    s_add_u32 s15, s15, s14
    s_mul_i32 s15, s15, 40960
    v_mov_b32 v4, s15
    s_waitcnt lgkmcnt(0)
    v_cmp_eq_u32 vcc, 0, v7
    s_and_saveexec_b64 s[16:17], vcc
    global_load_dword v122, v4, s[38:39]
    s_mov_b64 exec, s[16:17]
    s_waitcnt lgkmcnt(0)
F_TLX:
    s_mov_b32 s36, 0
    s_cmp_ge_u32 s25, 9
    s_cbranch_scc1 F_R0
    s_cmp_lt_u32 s25, 5
    s_cbranch_scc1 F_R0
    s_cmp_lt_u32 s2, 8
    s_cbranch_scc1 F_RW
    s_cmp_lg_u32 s25, 5
    s_cbranch_scc1 F_R0
    s_branch F_R0
F_RW:
    s_mov_b32 s36, 1
    s_sub_u32 s14, s25, 5
    s_and_b32 s15, s2, 1
    s_lshr_b32 s16, s2, 1
    s_lshl_b32 s16, s16, 5
    s_add_u32 s16, s16, s15
    v_and_b32 v1, 15, v7
    v_lshlrev_b32 v1, 1, v1
    v_add_u32 v1, s16, v1
    v_lshrrev_b32 v2, 4, v7
    v_lshlrev_b32 v2, 3, v2
    s_lshl_b32 s17, s14, 5
    v_add_u32 v2, s17, v2
    v_lshlrev_b32 v2, 7, v2
    v_add_u32 v2, v2, v1
    v_lshlrev_b32 v2, 1, v2
    global_load_ushort v8, v2, s[30:31] offset:0
    global_load_ushort v9, v2, s[30:31] offset:256
    global_load_ushort v10, v2, s[30:31] offset:512
    global_load_ushort v11, v2, s[30:31] offset:768
    global_load_ushort v12, v2, s[30:31] offset:1024
    global_load_ushort v13, v2, s[30:31] offset:1280
    global_load_ushort v14, v2, s[30:31] offset:1536
    global_load_ushort v15, v2, s[30:31] offset:1792
F_R0:
    s_barrier
    s_barrier
    s_barrier
    s_cmp_eq_u32 s36, 0
    s_cbranch_scc1 F_JOIN
    s_waitcnt vmcnt(0)
    s_lshl_b32 s17, s2, 12
    s_lshl_b32 s15, s14, 10
    s_add_u32 s17, s17, s15
    s_add_u32 s17, s17, 4096
    v_lshlrev_b32 v3, 4, v7
    v_add_u32 v3, s17, v3
    v_lshl_or_b32 v16, v9, 16, v8
    v_lshl_or_b32 v17, v11, 16, v10
    v_lshl_or_b32 v18, v13, 16, v12
    v_lshl_or_b32 v19, v15, 16, v14
    global_store_dwordx4 v3, v[16:19], s[18:19] sc1
F_RD:
F_JOIN:
    s_waitcnt vmcnt(0)
F_JOIN2:
    s_barrier
F_AFTERD:
    s_cmp_lg_u32 s25, 0
    s_cbranch_scc1 F_WAIT
    s_mov_b32 s14, 0
    v_mov_b32 v1, 0
    v_readfirstlane_b32 s74, v67
    s_nop 3
    s_cmp_lg_u32 s74, 0
    s_cbranch_scc1 F_GOTN
F_GETN:
    global_load_dword v2, v1, s[72:73] sc1
    s_waitcnt vmcnt(0)
    v_readfirstlane_b32 s74, v2
    s_add_u32 s14, s14, 1
    s_cmp_ge_u32 s14, 0x100000
    s_cbranch_scc1 F_GOTN
    s_cmp_eq_u32 s74, 0
    s_cbranch_scc1 F_GETN
F_GOTN:
    s_add_u32 s76, s12, 6946816
    s_addc_u32 s77, s13, 0
    s_lshl_b32 s14, s2, 2
    v_lshlrev_b32 v1, 10, v7
    v_add_u32 v1, s14, v1
    v_mov_b32 v2, s74
    v_cmp_gt_u32 vcc, 8, v7
    s_and_saveexec_b64 s[16:17], vcc
    global_store_dword v1, v2, s[76:77] sc1
    s_mov_b64 exec, s[16:17]
F_WAIT:
    s_load_dwordx2 s[4:5], s[0:1], 0
    s_load_dwordx2 s[6:7], s[0:1], 64
    s_load_dwordx2 s[8:9], s[0:1], 80
    s_load_dwordx2 s[26:27], s[0:1], 40
    s_load_dwordx2 s[78:79], s[0:1], 48
    v_and_b32 v1, 63, v0
    v_lshrrev_b32 v2, 6, v0
    v_lshlrev_b32 v57, 4, v1
    v_readfirstlane_b32 s16, v2
    v_mov_b32 v59, v57
    v_mov_b32 v61, v57
    v_mov_b32 v63, v57
    s_and_b32 s36, s2, 7
    s_mul_i32 s17, s36, 31
    s_min_u32 s36, s36, 2
    s_add_u32 s17, s17, s36
    s_lshr_b32 s36, s2, 3
    s_add_u32 s17, s17, s36
    s_lshr_b32 s28, s16, 1
    s_and_b32 s23, s16, 1
    s_mul_i32 s29, s16, 160
    v_mov_b32 v8, 0
    v_mov_b32 v9, 0
    v_mov_b32 v10, 0
    v_mov_b32 v11, 0
    v_mov_b32 v12, 0
    v_mov_b32 v13, 0
    v_mov_b32 v14, 0
    v_mov_b32 v15, 0
    v_mov_b32 v16, 0
    v_mov_b32 v17, 0
    v_mov_b32 v18, 0
    v_mov_b32 v19, 0
    v_mov_b32 v20, 0
    v_mov_b32 v21, 0
    v_mov_b32 v22, 0
    v_mov_b32 v23, 0
    v_mov_b32 v24, 0
    v_mov_b32 v25, 0
    v_mov_b32 v26, 0
    v_mov_b32 v27, 0
    v_mov_b32 v28, 0
    v_mov_b32 v29, 0
    v_mov_b32 v30, 0
    v_mov_b32 v31, 0
    v_mov_b32 v32, 0
    v_mov_b32 v33, 0
    v_mov_b32 v34, 0
    v_mov_b32 v35, 0
    v_mov_b32 v36, 0
    v_mov_b32 v37, 0
    v_mov_b32 v38, 0
    v_mov_b32 v39, 0
    v_mov_b32 v40, 0
    v_mov_b32 v41, 0
    v_mov_b32 v42, 0
    v_mov_b32 v43, 0
    v_mov_b32 v44, 0
    v_mov_b32 v45, 0
    v_mov_b32 v46, 0
    v_mov_b32 v47, 0
    s_waitcnt lgkmcnt(0)
    s_lshl_b32 s36, s17, 2
    s_add_u32 s56, s8, 6488064
    s_addc_u32 s57, s9, 0
    s_add_u32 s56, s56, s36
    s_addc_u32 s57, s57, 0
    s_add_u32 s58, s8, 6815744
    s_addc_u32 s59, s9, 0
    s_mov_b32 s19, 0
    s_mov_b32 s20, 2048
    s_mov_b32 s40, 1288
    s_mov_b32 s41, 2576
    s_mov_b32 s42, 3864
    v_lshlrev_b32 v2, 4, v0
    v_mov_b32 v120, 0
    v_mov_b32 v121, 0
    v_mov_b32 v122, 0
    v_mov_b32 v123, 0
    v_cmp_gt_u32 vcc, 800, v0
    s_and_saveexec_b64 s[24:25], vcc
    s_cbranch_execz K2_ZF0
    ds_write_b128 v2, v[120:123]
K2_ZF0:
    s_mov_b64 exec, -1
    v_add_u32 v2, 27264, v2
    ds_write_b128 v2, v[120:123] offset:0
    ds_write_b128 v2, v[120:123] offset:16384
    ds_write_b128 v2, v[120:123] offset:32768
    ds_write_b128 v2, v[120:123] offset:49152
    v_add_u32 v2, 65536, v2
    ds_write_b128 v2, v[120:123] offset:0
    ds_write_b128 v2, v[120:123] offset:16384
    v_cmp_gt_u32 vcc, 384, v0
    s_and_saveexec_b64 s[24:25], vcc
    s_cbranch_execz K2_ZF1
    ds_write_b128 v2, v[120:123] offset:32768
K2_ZF1:
    s_mov_b64 exec, -1
    s_mov_b32 s31, 0
    v_lshlrev_b32 v3, 2, v1
    global_load_dword v64, v3, s[26:27] offset:0
    global_load_dword v65, v3, s[26:27] offset:256
    global_load_dword v66, v3, s[26:27] offset:512
    global_load_dword v67, v3, s[26:27] offset:768
    v_and_b32 v2, 3, v1
    v_lshlrev_b32 v2, 5, v2
    global_load_dwordx2 v[68:69], v2, s[78:79] offset:0
    global_load_dwordx2 v[70:71], v2, s[78:79] offset:8
    global_load_dwordx2 v[72:73], v2, s[78:79] offset:16
    global_load_dwordx2 v[74:75], v2, s[78:79] offset:24
    s_waitcnt vmcnt(4)
    s_mov_b32 s36, 0xbfb8aa3b
    s_mov_b32 s37, 0xffff0000
    v_lshlrev_b32 v96, 16, v64
    v_and_b32 v100, s37, v64
    v_lshlrev_b32 v97, 16, v65
    v_and_b32 v101, s37, v65
    v_lshlrev_b32 v98, 16, v66
    v_and_b32 v102, s37, v66
    v_lshlrev_b32 v99, 16, v67
    v_and_b32 v103, s37, v67
    v_mul_f32 v96, s36, v96
    v_mul_f32 v97, s36, v97
    v_mul_f32 v98, s36, v98
    v_mul_f32 v99, s36, v99
    v_mul_f32 v100, s36, v100
    v_mul_f32 v101, s36, v101
    v_mul_f32 v102, s36, v102
    v_mul_f32 v103, s36, v103
    v_cvt_pk_bf16_f32 v48, v96, v97
    v_cvt_pk_bf16_f32 v49, v98, v99
    v_cvt_pk_bf16_f32 v50, v100, v101
    v_cvt_pk_bf16_f32 v51, v102, v103
    s_waitcnt vmcnt(0)
    s_mov_b32 s36, 0x05040100
    s_mov_b32 s37, 0x07060302
    v_perm_b32 v80, v70, v68, s36
    v_perm_b32 v81, v74, v72, s36
    v_perm_b32 v82, v70, v68, s37
    v_perm_b32 v83, v74, v72, s37
    v_perm_b32 v84, v71, v69, s36
    v_perm_b32 v85, v75, v73, s36
    v_perm_b32 v86, v71, v69, s37
    v_perm_b32 v87, v75, v73, s37
    s_mov_b32 s12, s4
    s_and_b32 s13, s5, 0xffff
    s_or_b32 s13, s13, 67108864
    s_mov_b32 s14, 10000
    s_mov_b32 s15, 0x00020000
    s_add_u32 s48, s8, 0
    s_addc_u32 s49, s9, 0
    s_and_b32 s49, s49, 0xffff
    s_mov_b32 s50, 1288000
    s_mov_b32 s51, 0x00020000
    s_add_u32 s52, s8, 1310720
    s_addc_u32 s53, s9, 0
    s_and_b32 s53, s53, 0xffff
    s_mov_b32 s54, 5152000
    s_mov_b32 s55, 0x00020000
    s_mov_b32 s44, 0xbf317218
    s_mov_b32 s45, 0xbf317218
    s_mov_b32 s60, s4
    s_and_b32 s61, s5, 0xffff
    s_mov_b32 s62, 10240000
    s_mov_b32 s63, 0x00020000
    s_add_u32 s76, s8, 6946816
    s_addc_u32 s77, s9, 0
    s_cmp_lg_u32 s16, 0
    s_cbranch_scc1 F_REL
    s_mov_b32 s36, 0
    s_and_b32 s37, s2, 7
    s_lshl_b32 s37, s37, 10
    v_add_u32 v3, s37, v57
    v_cmp_gt_u32 s[64:65], 63, v1
    v_cmp_gt_u32 s[66:67], 62, v1
F_POLL:
    global_load_dwordx4 v[64:67], v3, s[76:77] sc1
    s_waitcnt vmcnt(0)
    v_cmp_eq_u32 vcc, s74, v64
    s_andn2_b64 s[68:69], s[64:65], vcc
    v_cmp_eq_u32 vcc, s74, v65
    s_andn2_b64 s[70:71], s[64:65], vcc
    v_cmp_eq_u32 vcc, s74, v66
    s_andn2_b64 s[32:33], s[66:67], vcc
    v_cmp_eq_u32 vcc, s74, v67
    s_andn2_b64 s[34:35], s[66:67], vcc
    s_or_b64 s[68:69], s[68:69], s[70:71]
    s_or_b64 s[32:33], s[32:33], s[34:35]
    s_or_b64 s[68:69], s[68:69], s[32:33]
    s_add_u32 s36, s36, 1
    s_cmp_ge_u32 s36, 0x100000
    s_cbranch_scc1 F_REL
    s_cmp_eq_u64 s[68:69], 0
    s_cbranch_scc1 F_REL
    s_branch F_POLL
F_REL:
    s_barrier
    v_lshlrev_b32 v3, 5, v1
    v_mov_b32 v4, 0
    s_cmp_ge_u32 s16, 4
    s_cbranch_scc1 K2_NOCL
    v_lshlrev_b32 v5, 10, v0
    v_cmp_gt_u32 vcc, 250, v0
    s_and_saveexec_b64 s[24:25], vcc
    global_load_dword v4, v5, s[56:57] sc1
    s_mov_b64 exec, -1
K2_NOCL:
    s_cmp_ge_u32 s16, 4
    s_cbranch_scc1 K2_NOCW
    s_waitcnt vmcnt(0)
    v_lshlrev_b32 v5, 2, v0
    v_add_u32 v5, 132736, v5
    ds_write_b32 v5, v4
    s_waitcnt lgkmcnt(0)
K2_NOCW:
    s_barrier
    v_add_u32 v5, 132736, v57
    ds_read_b128 v[68:71], v5
    s_branch K2_ROUND1
K2_ROUND:
    s_mov_b32 s31, 1
    v_lshlrev_b32 v3, 5, v1
    v_add_u32 v5, 132736, v57
    ds_read_b128 v[68:71], v5
    s_waitcnt lgkmcnt(0)
    v_mov_b32 v122, v68
    v_mov_b32 v123, v69
    v_mov_b32 v124, v70
    v_mov_b32 v125, v71
    v_and_b32 v2, 3, v1
    v_lshlrev_b32 v2, 5, v2
    global_load_dwordx2 v[68:69], v2, s[78:79] offset:0
    global_load_dwordx2 v[70:71], v2, s[78:79] offset:8
    global_load_dwordx2 v[72:73], v2, s[78:79] offset:16
    global_load_dwordx2 v[74:75], v2, s[78:79] offset:24
    s_waitcnt vmcnt(0)
    s_mov_b32 s36, 0x05040100
    s_mov_b32 s37, 0x07060302
    v_perm_b32 v80, v70, v68, s36
    v_perm_b32 v81, v74, v72, s36
    v_perm_b32 v82, v70, v68, s37
    v_perm_b32 v83, v74, v72, s37
    v_perm_b32 v84, v71, v69, s36
    v_perm_b32 v85, v75, v73, s36
    v_perm_b32 v86, v71, v69, s37
    v_perm_b32 v87, v75, v73, s37
    v_mov_b32 v68, v122
    v_mov_b32 v69, v123
    v_mov_b32 v70, v124
    v_mov_b32 v71, v125
K2_ROUND1:
    v_lshlrev_b32 v2, 2, v0
    v_mov_b32 v3, 0
    v_cmp_gt_u32 vcc, 256, v0
    s_and_saveexec_b64 s[24:25], vcc
    s_cbranch_execz K2_NOZ
    ds_write_b32 v2, v3 offset:12800
K2_NOZ:
    s_mov_b64 exec, -1
    s_waitcnt lgkmcnt(0)
    v_mul_u32_u24 v2, 5152, v1
    v_and_b32 v64, 0xffff, v68
    v_lshrrev_b32 v68, 16, v68
    v_add_u32 v64, v64, v2
    v_and_b32 v65, 0xffff, v69
    v_lshrrev_b32 v69, 16, v69
    v_add3_u32 v65, v65, v2, s40
    v_and_b32 v66, 0xffff, v70
    v_lshrrev_b32 v70, 16, v70
    v_add3_u32 v66, v66, v2, s41
    v_and_b32 v67, 0xffff, v71
    v_lshrrev_b32 v71, 16, v71
    v_add3_u32 v67, v67, v2, s42
    v_add_u32 v3, v68, v69
    v_add_u32 v4, v3, v70
    v_add_u32 v5, v4, v71
    v_max3_u32 v7, v68, v69, v70
    v_mov_b32 v6, v5
    v_max_u32 v7, v7, v71
    s_nop 1
    v_add_u32_dpp v6, v6, v6 row_shr:1 row_mask:0xf bank_mask:0xf bound_ctrl:1
    s_nop 1
    v_add_u32_dpp v6, v6, v6 row_shr:2 row_mask:0xf bank_mask:0xf bound_ctrl:1
    s_nop 1
    v_add_u32_dpp v6, v6, v6 row_shr:4 row_mask:0xf bank_mask:0xf bound_ctrl:1
    s_nop 1
    v_add_u32_dpp v6, v6, v6 row_shr:8 row_mask:0xf bank_mask:0xf bound_ctrl:1
    s_nop 1
    v_add_u32_dpp v6, v6, v6 row_bcast:15 row_mask:0xa bank_mask:0xf
    s_nop 1
    v_add_u32_dpp v6, v6, v6 row_bcast:31 row_mask:0xc bank_mask:0xf
    v_sub_u32 v72, v6, v5
    v_add_u32 v73, v72, v68
    v_add_u32 v74, v72, v3
    v_add_u32 v75, v72, v4
    v_readlane_b32 s18, v6, 63
    v_mov_b32 v120, 8192
    s_mov_b32 s22, s16
    s_cmp_eq_u32 s18, 0
    s_cbranch_scc1 K2_EPI
K2_EX:
    v_cmp_lt_u32 vcc, s22, v7
    s_cbranch_vccz K2_EXD
    s_sub_u32 s36, s22, s19
    v_add_u32 v2, s36, v72
    v_cmp_lt_u32 vcc, s22, v68
    v_cmp_gt_u32 s[26:27], s20, v2
    v_lshlrev_b32 v2, 2, v2
    v_add_u32 v3, s22, v64
    s_and_b64 vcc, vcc, s[26:27]
    v_cndmask_b32 v2, v120, v2, vcc
    ds_write_b32 v2, v3 offset:19008
    v_add_u32 v2, s36, v73
    v_cmp_lt_u32 vcc, s22, v69
    v_cmp_gt_u32 s[26:27], s20, v2
    v_lshlrev_b32 v2, 2, v2
    v_add_u32 v3, s22, v65
    s_and_b64 vcc, vcc, s[26:27]
    v_cndmask_b32 v2, v120, v2, vcc
    ds_write_b32 v2, v3 offset:19008
    v_add_u32 v2, s36, v74
    v_cmp_lt_u32 vcc, s22, v70
    v_cmp_gt_u32 s[26:27], s20, v2
    v_lshlrev_b32 v2, 2, v2
    v_add_u32 v3, s22, v66
    s_and_b64 vcc, vcc, s[26:27]
    v_cndmask_b32 v2, v120, v2, vcc
    ds_write_b32 v2, v3 offset:19008
    v_add_u32 v2, s36, v75
    v_cmp_lt_u32 vcc, s22, v71
    v_cmp_gt_u32 s[26:27], s20, v2
    v_lshlrev_b32 v2, 2, v2
    v_add_u32 v3, s22, v67
    s_and_b64 vcc, vcc, s[26:27]
    v_cndmask_b32 v2, v120, v2, vcc
    ds_write_b32 v2, v3 offset:19008
    s_add_u32 s22, s22, 16
    s_branch K2_EX
K2_EXD:
    s_waitcnt lgkmcnt(0)
    s_barrier
    v_lshlrev_b32 v2, 2, v0
    ds_read_b32 v116, v2 offset:19008
    ds_read_b32 v117, v2 offset:23104
    v_mov_b32 v4, 0
    v_mov_b32 v5, 0
    v_mov_b32 v3, 18944
    ds_write_b64 v3, v[4:5]
    s_sub_u32 s21, s18, s19
    s_min_u32 s21, s21, s20
    s_lshl_b32 s36, s16, 6
    s_waitcnt lgkmcnt(1)
    s_add_u32 s37, s36, 0
    s_cmp_ge_u32 s37, s21
    s_cbranch_scc1 K2_LD_DONE
    v_add_u32 v3, 0, v0
    v_cmp_gt_u32 vcc, s21, v3
    v_lshlrev_b32 v4, 2, v116
    v_lshlrev_b32 v5, 4, v116
    s_and_saveexec_b64 s[24:25], vcc
    buffer_load_dword v88, v4, s[48:51], 0 offen sc1
    buffer_load_dwordx4 v[92:95], v5, s[52:55], 0 offen sc1
    s_mov_b64 exec, -1
    s_add_u32 s37, s36, 1024
    s_cmp_ge_u32 s37, s21
    s_cbranch_scc1 K2_LD_DONE
    v_add_u32 v3, 1024, v0
    v_cmp_gt_u32 vcc, s21, v3
    v_lshlrev_b32 v4, 2, v117
    v_lshlrev_b32 v5, 4, v117
    s_and_saveexec_b64 s[24:25], vcc
    buffer_load_dword v89, v4, s[48:51], 0 offen sc1
    buffer_load_dwordx4 v[96:99], v5, s[52:55], 0 offen sc1
    s_mov_b64 exec, -1
K2_LD_DONE:
    v_mov_b32 v6, 1
    s_waitcnt vmcnt(0)
    s_cmp_ge_u32 s16, 5
    s_cbranch_scc1 K2_NOPF0
    s_mul_i32 s65, s2, 40960
    s_lshl_b32 s38, s16, 13
    s_add_u32 s65, s65, s38
    v_lshlrev_b32 v126, 7, v1
    buffer_load_dword v127, v126, s[60:63], s65 offen
K2_NOPF0:
    s_add_u32 s37, s36, 0
    s_cmp_ge_u32 s37, s21
    s_cbranch_scc1 K2_H_DONE
    v_add_u32 v3, 0, v0
    v_lshrrev_b32 v118, 17, v88
    v_cmp_gt_u32 vcc, s21, v3
    v_lshlrev_b32 v4, 2, v118
    s_and_saveexec_b64 s[24:25], vcc
    ds_add_rtn_u32 v90, v4, v6 offset:12800
    s_mov_b64 exec, -1
    v_mfma_f32_4x4x4_16b_bf16 v[64:67], v[80:81], v[92:93], 0
    v_mfma_f32_4x4x4_16b_bf16 v[68:71], v[82:83], v[92:93], 0
    v_mfma_f32_4x4x4_16b_bf16 v[72:75], v[84:85], v[92:93], 0
    v_mfma_f32_4x4x4_16b_bf16 v[76:79], v[86:87], v[92:93], 0
    s_nop 4
    v_cvt_pk_bf16_f32 v100, v64, v65
    v_cvt_pk_bf16_f32 v101, v66, v67
    v_cvt_pk_bf16_f32 v102, v68, v69
    v_cvt_pk_bf16_f32 v103, v70, v71
    v_cvt_pk_bf16_f32 v104, v72, v73
    v_cvt_pk_bf16_f32 v105, v74, v75
    v_cvt_pk_bf16_f32 v106, v76, v77
    v_cvt_pk_bf16_f32 v107, v78, v79
    s_add_u32 s37, s36, 1024
    s_cmp_ge_u32 s37, s21
    s_cbranch_scc1 K2_H_DONE
    v_add_u32 v3, 1024, v0
    v_lshrrev_b32 v119, 17, v89
    v_cmp_gt_u32 vcc, s21, v3
    v_lshlrev_b32 v4, 2, v119
    s_and_saveexec_b64 s[24:25], vcc
    ds_add_rtn_u32 v91, v4, v6 offset:12800
    s_mov_b64 exec, -1
    v_mfma_f32_4x4x4_16b_bf16 v[64:67], v[80:81], v[96:97], 0
    v_mfma_f32_4x4x4_16b_bf16 v[68:71], v[82:83], v[96:97], 0
    v_mfma_f32_4x4x4_16b_bf16 v[72:75], v[84:85], v[96:97], 0
    v_mfma_f32_4x4x4_16b_bf16 v[76:79], v[86:87], v[96:97], 0
    s_nop 4
    v_cvt_pk_bf16_f32 v108, v64, v65
    v_cvt_pk_bf16_f32 v109, v66, v67
    v_cvt_pk_bf16_f32 v110, v68, v69
    v_cvt_pk_bf16_f32 v111, v70, v71
    v_cvt_pk_bf16_f32 v112, v72, v73
    v_cvt_pk_bf16_f32 v113, v74, v75
    v_cvt_pk_bf16_f32 v114, v76, v77
    v_cvt_pk_bf16_f32 v115, v78, v79
K2_H_DONE:
    s_waitcnt lgkmcnt(0)
    s_barrier
    s_lshl_b32 s37, s28, 7
    v_lshlrev_b32 v2, 2, v1
    v_add_u32 v2, s37, v2
    v_mov_b32 v3, 0
    v_cmp_gt_u32 vcc, 32, v1
    s_and_saveexec_b64 s[24:25], vcc
    ds_read_b32 v3, v2 offset:12800
    s_mov_b64 exec, -1
    v_add_u32 v4, s23, v1
    v_and_b32 v4, 1, v4
    v_lshlrev_b32 v2, 1, v2
    s_lshl_b32 s38, s23, 2
    v_add_u32 v2, s38, v2
    s_waitcnt lgkmcnt(0)
    v_sub_u32 v3, v3, v4
    v_add_u32 v3, 1, v3
    v_lshrrev_b32 v3, 1, v3
    v_mov_b32 v4, v3
    s_nop 1
    v_add_u32_dpp v4, v4, v4 row_shr:1 row_mask:0xf bank_mask:0xf bound_ctrl:1
    s_nop 1
    v_add_u32_dpp v4, v4, v4 row_shr:2 row_mask:0xf bank_mask:0xf bound_ctrl:1
    s_nop 1
    v_add_u32_dpp v4, v4, v4 row_shr:4 row_mask:0xf bank_mask:0xf bound_ctrl:1
    s_nop 1
    v_add_u32_dpp v4, v4, v4 row_shr:8 row_mask:0xf bank_mask:0xf bound_ctrl:1
    s_nop 1
    v_add_u32_dpp v4, v4, v4 row_bcast:15 row_mask:0xa bank_mask:0xf
    s_nop 0
    v_readlane_b32 s35, v4, 31
    v_sub_u32 v4, v4, v3
    v_add_u32 v4, s29, v4
    v_cmp_gt_u32 vcc, 32, v1
    s_and_saveexec_b64 s[24:25], vcc
    ds_write_b32 v2, v4 offset:14848
    s_mov_b64 exec, -1
    s_cmp_gt_u32 s35, 152
    s_cbranch_scc0 K2_NOOVF
    v_mov_b32 v2, 1
    v_mov_b32 v3, 18944
    ds_write_b32 v3, v2
    s_branch K2_PADDONE
K2_NOOVF:
K2_PADDONE:
    s_waitcnt lgkmcnt(0)
    s_barrier
    v_mov_b32 v3, 18944
    ds_read_b32 v2, v3
    v_add_u32 v4, v90, v118
    v_and_b32 v4, 1, v4
    v_lshl_add_u32 v4, v118, 1, v4
    v_lshlrev_b32 v4, 2, v4
    ds_read_b32 v116, v4 offset:14848
    v_add_u32 v4, v91, v119
    v_and_b32 v4, 1, v4
    v_lshl_add_u32 v4, v119, 1, v4
    v_lshlrev_b32 v4, 2, v4
    ds_read_b32 v117, v4 offset:14848
    s_waitcnt lgkmcnt(0)
    v_readfirstlane_b32 s37, v2
    s_nop 3
    s_cmp_eq_u32 s37, 0
    s_cbranch_scc1 K2_PLACE
    s_mov_b32 s20, 200
    s_branch K2_ROUND
K2_PLACE:
    s_cmp_eq_u32 s31, 0
    s_cbranch_scc1 K2_NOPADS
    s_add_u32 s38, s29, s35
    v_add_u32 v2, s38, v1
    v_lshlrev_b32 v3, 2, v2
    v_lshlrev_b32 v4, 3, v2
    s_mul_i32 s39, s16, 2688
    s_add_u32 s39, s39, 47744
    v_lshlrev_b32 v5, 4, v2
    v_add_u32 v5, s39, v5
    v_mov_b32 v120, 0
    v_mov_b32 v121, 0
    v_mov_b32 v122, 0
    v_mov_b32 v123, 0
    v_cmp_gt_u32 vcc, 8, v1
    s_and_saveexec_b64 s[24:25], vcc
    ds_write_b32 v3, v120 offset:0
    ds_write_b8 v2, v120 offset:10240
    v_cmp_gt_u32 vcc, 4, v1
    s_and_b64 exec, exec, vcc
    ds_write_b64 v4, v[120:121] offset:27264
    ds_write_b128 v5, v[120:123]
    ds_write_b128 v5, v[120:123] offset:2688
    s_mov_b64 exec, -1
K2_NOPADS:
    s_add_u32 s37, s36, 0
    s_cmp_ge_u32 s37, s21
    s_cbranch_scc1 K2_P_DONE
    v_add_u32 v3, 0, v0
    v_cmp_gt_u32 vcc, s21, v3
    v_lshrrev_b32 v2, 1, v90
    v_add_u32 v116, v116, v2
    v_lshlrev_b32 v2, 2, v116
    v_lshlrev_b32 v3, 3, v116
    v_mul_u32_u24 v4, 26215, v116
    v_lshrrev_b32 v4, 22, v4
    v_mul_u32_u24 v4, 2688, v4
    v_lshl_add_u32 v4, v116, 4, v4
    v_add_u32 v4, 47744, v4
    v_and_b32 v5, 0x3fff, v88
    v_lshrrev_b32 v6, 11, v88
    v_and_b32 v6, 0x38, v6
    s_and_saveexec_b64 s[24:25], vcc
    ds_write_b128 v4, v[100:103]
    ds_write_b128 v4, v[104:107] offset:2688
    ds_write_b64 v3, v[94:95] offset:27264
    ds_write_b32 v2, v5 offset:0
    ds_write_b8 v116, v6 offset:10240
    s_mov_b64 exec, -1
    s_add_u32 s37, s36, 1024
    s_cmp_ge_u32 s37, s21
    s_cbranch_scc1 K2_P_DONE
    v_add_u32 v3, 1024, v0
    v_cmp_gt_u32 vcc, s21, v3
    v_lshrrev_b32 v2, 1, v91
    v_add_u32 v117, v117, v2
    v_lshlrev_b32 v2, 2, v117
    v_lshlrev_b32 v3, 3, v117
    v_mul_u32_u24 v4, 26215, v117
    v_lshrrev_b32 v4, 22, v4
    v_mul_u32_u24 v4, 2688, v4
    v_lshl_add_u32 v4, v117, 4, v4
    v_add_u32 v4, 47744, v4
    v_and_b32 v5, 0x3fff, v89
    v_lshrrev_b32 v6, 11, v89
    v_and_b32 v6, 0x38, v6
    s_and_saveexec_b64 s[24:25], vcc
    ds_write_b128 v4, v[108:111]
    ds_write_b128 v4, v[112:115] offset:2688
    ds_write_b64 v3, v[98:99] offset:27264
    ds_write_b32 v2, v5 offset:0
    ds_write_b8 v117, v6 offset:10240
    s_mov_b64 exec, -1
K2_P_DONE:
    s_waitcnt lgkmcnt(0)
    s_barrier
    s_cmp_eq_u32 s35, 0
    s_cbranch_scc1 K2_MAIN_DONE
    s_add_u32 s67, s35, 3
    s_lshr_b32 s67, s67, 2
    s_sub_u32 s34, 0, s67
    s_lshl_b32 s36, s29, 2
    v_mov_b32 v5, s36
    v_mov_b32 v6, s29
    s_mul_i32 s36, s16, 5248
    s_add_u32 s36, s36, 47744
    v_lshrrev_b32 v2, 2, v1
    v_lshlrev_b32 v2, 4, v2
    v_and_b32 v3, 1, v1
    v_lshl_add_u32 v2, v3, 3, v2
    v_bfe_u32 v3, v1, 1, 1
    v_mul_u32_u24 v3, 2688, v3
    v_add3_u32 v3, v3, v2, s36
    v_lshlrev_b32 v2, 3, v1
    s_lshl_b32 s36, s29, 3
    s_add_u32 s36, s36, 27264
    v_add_u32 v4, s36, v2
    s_setprio 3
    ds_read_b32 v56, v5 offset:0
    ds_read_b32 v58, v5 offset:4
    ds_read_b32 v60, v5 offset:8
    ds_read_b32 v62, v5 offset:12
    ds_read_b64 v[88:89], v3
    ds_read_b64 v[92:93], v4
    ds_read_b32 v7, v6 offset:10240
    s_waitcnt lgkmcnt(3)
    buffer_load_dwordx4 v[64:67], v[56:57], s[12:15], 0 idxen offen
    buffer_load_dwordx4 v[68:71], v[58:59], s[12:15], 0 idxen offen
    buffer_load_dwordx4 v[72:75], v[60:61], s[12:15], 0 idxen offen
    buffer_load_dwordx4 v[76:79], v[62:63], s[12:15], 0 idxen offen
    ds_read_b32 v56, v5 offset:16
    ds_read_b32 v58, v5 offset:20
    ds_read_b32 v60, v5 offset:24
    ds_read_b32 v62, v5 offset:28
    s_lshr_b32 s70, s16, 2
    s_lshl_b32 s70, s70, 1
    s_sub_i32 s70, s70, 3
    s_mul_i32 s70, s70, 3
    s_sub_i32 s71, 48, s70
    s_mul_i32 s71, s71, s67
    s_ashr_i32 s71, s71, 6
    s_max_i32 s71, s71, 1
    s_sub_i32 s68, 0, s71
    s_sub_i32 s71, 32, s70
    s_mul_i32 s71, s71, s67
    s_ashr_i32 s71, s71, 6
    s_max_i32 s71, s71, 1
    s_sub_i32 s69, 0, s71
    s_sub_i32 s71, 16, s70
    s_mul_i32 s71, s71, s67
    s_ashr_i32 s71, s71, 6
    s_max_i32 s71, s71, 1
    s_sub_i32 s70, 0, s71
    s_mov_b32 s43, 2
    s_mov_b32 s46, s68
    s_waitcnt lgkmcnt(5)
    v_mfma_f32_4x4x4_16b_bf16 v[96:99], v[92:93], v[48:49], 0 cbsz:4 abid:0
    v_mfma_f32_4x4x4_16b_bf16 v[100:103], v[92:93], v[50:51], 0 cbsz:4 abid:0
    v_mfma_f32_4x4x4_16b_bf16 v[104:107], v[92:93], v[48:49], 0 cbsz:4 abid:1
    v_mfma_f32_4x4x4_16b_bf16 v[108:111], v[92:93], v[50:51], 0 cbsz:4 abid:1
    s_nop 2
    v_exp_f32 v112, v96
    v_exp_f32 v113, v97
    v_exp_f32 v114, v98
    v_exp_f32 v115, v99
    v_exp_f32 v116, v100
    v_exp_f32 v117, v101
    v_exp_f32 v118, v102
    v_exp_f32 v119, v103
    s_nop 0
    v_pk_add_f32 v[112:113], v[112:113], 1.0 op_sel_hi:[1,0]
    v_pk_add_f32 v[114:115], v[114:115], 1.0 op_sel_hi:[1,0]
    v_pk_add_f32 v[116:117], v[116:117], 1.0 op_sel_hi:[1,0]
    v_pk_add_f32 v[118:119], v[118:119], 1.0 op_sel_hi:[1,0]
    v_rcp_f32 v112, v112
    v_rcp_f32 v113, v113
    v_rcp_f32 v114, v114
    v_rcp_f32 v115, v115
    v_rcp_f32 v116, v116
    v_rcp_f32 v117, v117
    v_rcp_f32 v118, v118
    v_rcp_f32 v119, v119
    s_nop 0
    v_pk_mul_f32 v[120:121], v[96:97], v[112:113]
    v_pk_mul_f32 v[122:123], v[98:99], v[114:115]
K2_LOOP:
    s_waitcnt lgkmcnt(0)
    v_readfirstlane_b32 s32, v7
    s_cmp_ge_i32 s34, s46
    s_cbranch_scc1 K2_PR0
K2_PRR0:
    ds_read_b32 v7, v6 offset:10244
    ds_read_b64 v[94:95], v4 offset:128
    ds_read_b64 v[90:91], v3 offset:256
    s_waitcnt vmcnt(3)
    v_mfma_f32_4x4x4_16b_bf16 v[80:83], v[88:89], v[64:65], 0 cbsz:4 abid:0
    v_exp_f32 v112, v104
    v_mfma_f32_4x4x4_16b_bf16 v[84:87], v[88:89], v[66:67], 0 cbsz:4 abid:0
    v_exp_f32 v113, v105
    buffer_load_dwordx4 v[64:67], v[56:57], s[12:15], 0 idxen offen
    ds_read_b32 v56, v5 offset:32
    v_mfma_f32_4x4x4_16b_bf16 v[96:99], v[92:93], v[48:49], 0 cbsz:4 abid:2
    v_exp_f32 v114, v106
    v_exp_f32 v115, v107
    v_pk_mul_f32 v[124:125], v[100:101], v[116:117]
    v_pk_mul_f32 v[126:127], v[102:103], v[118:119]
    s_set_gpr_idx_on s32, gpr_idx(SRC2,DST)
    v_pk_fma_f32 v[8:9], v[80:81], v[120:121], v[8:9] op_sel_hi:[1,0,1]
    v_pk_fma_f32 v[10:11], v[82:83], v[120:121], v[10:11] op_sel_hi:[1,0,1]
    v_pk_fma_f32 v[12:13], v[84:85], v[124:125], v[12:13] op_sel_hi:[1,0,1]
    v_pk_fma_f32 v[14:15], v[86:87], v[124:125], v[14:15] op_sel_hi:[1,0,1]
    s_set_gpr_idx_off
    s_lshr_b32 s32, s32, 8
    s_waitcnt vmcnt(3)
    v_mfma_f32_4x4x4_16b_bf16 v[80:83], v[88:89], v[68:69], 0 cbsz:4 abid:1
    v_exp_f32 v116, v108
    v_mfma_f32_4x4x4_16b_bf16 v[84:87], v[88:89], v[70:71], 0 cbsz:4 abid:1
    v_exp_f32 v117, v109
    buffer_load_dwordx4 v[68:71], v[58:59], s[12:15], 0 idxen offen
    ds_read_b32 v58, v5 offset:36
    v_mfma_f32_4x4x4_16b_bf16 v[100:103], v[92:93], v[50:51], 0 cbsz:4 abid:2
    v_exp_f32 v118, v110
    v_exp_f32 v119, v111
    v_pk_add_f32 v[112:113], v[112:113], 1.0 op_sel_hi:[1,0]
    v_pk_add_f32 v[114:115], v[114:115], 1.0 op_sel_hi:[1,0]
    s_set_gpr_idx_on s32, gpr_idx(SRC2,DST)
    v_pk_fma_f32 v[8:9], v[80:81], v[120:121], v[8:9] op_sel:[0,1,0] op_sel_hi:[1,1,1]
    v_pk_fma_f32 v[10:11], v[82:83], v[120:121], v[10:11] op_sel:[0,1,0] op_sel_hi:[1,1,1]
    v_pk_fma_f32 v[12:13], v[84:85], v[124:125], v[12:13] op_sel:[0,1,0] op_sel_hi:[1,1,1]
    v_pk_fma_f32 v[14:15], v[86:87], v[124:125], v[14:15] op_sel:[0,1,0] op_sel_hi:[1,1,1]
    s_set_gpr_idx_off
    s_lshr_b32 s32, s32, 8
    s_waitcnt vmcnt(3)
    v_mfma_f32_4x4x4_16b_bf16 v[80:83], v[88:89], v[72:73], 0 cbsz:4 abid:2
    v_rcp_f32 v112, v112
    v_mfma_f32_4x4x4_16b_bf16 v[84:87], v[88:89], v[74:75], 0 cbsz:4 abid:2
    v_rcp_f32 v113, v113
    buffer_load_dwordx4 v[72:75], v[60:61], s[12:15], 0 idxen offen
    ds_read_b32 v60, v5 offset:40
    v_rcp_f32 v114, v114
    v_rcp_f32 v115, v115
    v_pk_add_f32 v[116:117], v[116:117], 1.0 op_sel_hi:[1,0]
    v_pk_add_f32 v[118:119], v[118:119], 1.0 op_sel_hi:[1,0]
    s_set_gpr_idx_on s32, gpr_idx(SRC2,DST)
    v_pk_fma_f32 v[8:9], v[80:81], v[122:123], v[8:9] op_sel_hi:[1,0,1]
    v_pk_fma_f32 v[10:11], v[82:83], v[122:123], v[10:11] op_sel_hi:[1,0,1]
    v_pk_fma_f32 v[12:13], v[84:85], v[126:127], v[12:13] op_sel_hi:[1,0,1]
    v_pk_fma_f32 v[14:15], v[86:87], v[126:127], v[14:15] op_sel_hi:[1,0,1]
    s_set_gpr_idx_off
    s_lshr_b32 s32, s32, 8
    s_waitcnt vmcnt(3)
    v_mfma_f32_4x4x4_16b_bf16 v[80:83], v[88:89], v[76:77], 0 cbsz:4 abid:3
    v_rcp_f32 v116, v116
    v_mfma_f32_4x4x4_16b_bf16 v[84:87], v[88:89], v[78:79], 0 cbsz:4 abid:3
    v_rcp_f32 v117, v117
    buffer_load_dwordx4 v[76:79], v[62:63], s[12:15], 0 idxen offen
    ds_read_b32 v62, v5 offset:44
    v_rcp_f32 v118, v118
    v_rcp_f32 v119, v119
    s_set_gpr_idx_on s32, gpr_idx(SRC2,DST)
    v_pk_fma_f32 v[8:9], v[80:81], v[122:123], v[8:9] op_sel:[0,1,0] op_sel_hi:[1,1,1]
    v_pk_fma_f32 v[10:11], v[82:83], v[122:123], v[10:11] op_sel:[0,1,0] op_sel_hi:[1,1,1]
    v_pk_fma_f32 v[12:13], v[84:85], v[126:127], v[12:13] op_sel:[0,1,0] op_sel_hi:[1,1,1]
    v_pk_fma_f32 v[14:15], v[86:87], v[126:127], v[14:15] op_sel:[0,1,0] op_sel_hi:[1,1,1]
    s_set_gpr_idx_off
    v_pk_mul_f32 v[120:121], v[104:105], v[112:113]
    v_pk_mul_f32 v[122:123], v[106:107], v[114:115]
    s_add_u32 s34, s34, 1
    s_cbranch_scc1 K2_MAIN_DONE
    s_waitcnt lgkmcnt(0)
    v_readfirstlane_b32 s32, v7
    s_cmp_ge_i32 s34, s46
    s_cbranch_scc1 K2_PR1
K2_PRR1:
    ds_read_b32 v7, v6 offset:10248
    s_waitcnt vmcnt(3)
    v_mfma_f32_4x4x4_16b_bf16 v[80:83], v[88:89], v[64:65], 0 cbsz:4 abid:4
    v_exp_f32 v112, v96
    v_mfma_f32_4x4x4_16b_bf16 v[84:87], v[88:89], v[66:67], 0 cbsz:4 abid:4
    v_exp_f32 v113, v97
    buffer_load_dwordx4 v[64:67], v[56:57], s[12:15], 0 idxen offen
    ds_read_b32 v56, v5 offset:48
    v_mfma_f32_4x4x4_16b_bf16 v[104:107], v[92:93], v[48:49], 0 cbsz:4 abid:3
    v_exp_f32 v114, v98
    v_exp_f32 v115, v99
    v_pk_mul_f32 v[124:125], v[108:109], v[116:117]
    v_pk_mul_f32 v[126:127], v[110:111], v[118:119]
    s_set_gpr_idx_on s32, gpr_idx(SRC2,DST)
    v_pk_fma_f32 v[8:9], v[80:81], v[120:121], v[8:9] op_sel_hi:[1,0,1]
    v_pk_fma_f32 v[10:11], v[82:83], v[120:121], v[10:11] op_sel_hi:[1,0,1]
    v_pk_fma_f32 v[12:13], v[84:85], v[124:125], v[12:13] op_sel_hi:[1,0,1]
    v_pk_fma_f32 v[14:15], v[86:87], v[124:125], v[14:15] op_sel_hi:[1,0,1]
    s_set_gpr_idx_off
    s_lshr_b32 s32, s32, 8
    s_waitcnt vmcnt(3)
    v_mfma_f32_4x4x4_16b_bf16 v[80:83], v[88:89], v[68:69], 0 cbsz:4 abid:5
    v_exp_f32 v116, v100
    v_mfma_f32_4x4x4_16b_bf16 v[84:87], v[88:89], v[70:71], 0 cbsz:4 abid:5
    v_exp_f32 v117, v101
    buffer_load_dwordx4 v[68:71], v[58:59], s[12:15], 0 idxen offen
    ds_read_b32 v58, v5 offset:52
    v_mfma_f32_4x4x4_16b_bf16 v[108:111], v[92:93], v[50:51], 0 cbsz:4 abid:3
    v_exp_f32 v118, v102
    v_exp_f32 v119, v103
    v_pk_add_f32 v[112:113], v[112:113], 1.0 op_sel_hi:[1,0]
    v_pk_add_f32 v[114:115], v[114:115], 1.0 op_sel_hi:[1,0]
    s_set_gpr_idx_on s32, gpr_idx(SRC2,DST)
    v_pk_fma_f32 v[8:9], v[80:81], v[120:121], v[8:9] op_sel:[0,1,0] op_sel_hi:[1,1,1]
    v_pk_fma_f32 v[10:11], v[82:83], v[120:121], v[10:11] op_sel:[0,1,0] op_sel_hi:[1,1,1]
    v_pk_fma_f32 v[12:13], v[84:85], v[124:125], v[12:13] op_sel:[0,1,0] op_sel_hi:[1,1,1]
    v_pk_fma_f32 v[14:15], v[86:87], v[124:125], v[14:15] op_sel:[0,1,0] op_sel_hi:[1,1,1]
    s_set_gpr_idx_off
    s_lshr_b32 s32, s32, 8
    s_waitcnt vmcnt(3)
    v_mfma_f32_4x4x4_16b_bf16 v[80:83], v[88:89], v[72:73], 0 cbsz:4 abid:6
    v_rcp_f32 v112, v112
    v_mfma_f32_4x4x4_16b_bf16 v[84:87], v[88:89], v[74:75], 0 cbsz:4 abid:6
    v_rcp_f32 v113, v113
    buffer_load_dwordx4 v[72:75], v[60:61], s[12:15], 0 idxen offen
    ds_read_b32 v60, v5 offset:56
    v_rcp_f32 v114, v114
    v_rcp_f32 v115, v115
    v_pk_add_f32 v[116:117], v[116:117], 1.0 op_sel_hi:[1,0]
    v_pk_add_f32 v[118:119], v[118:119], 1.0 op_sel_hi:[1,0]
    s_set_gpr_idx_on s32, gpr_idx(SRC2,DST)
    v_pk_fma_f32 v[8:9], v[80:81], v[122:123], v[8:9] op_sel_hi:[1,0,1]
    v_pk_fma_f32 v[10:11], v[82:83], v[122:123], v[10:11] op_sel_hi:[1,0,1]
    v_pk_fma_f32 v[12:13], v[84:85], v[126:127], v[12:13] op_sel_hi:[1,0,1]
    v_pk_fma_f32 v[14:15], v[86:87], v[126:127], v[14:15] op_sel_hi:[1,0,1]
    s_set_gpr_idx_off
    s_lshr_b32 s32, s32, 8
    s_waitcnt vmcnt(3)
    v_mfma_f32_4x4x4_16b_bf16 v[80:83], v[88:89], v[76:77], 0 cbsz:4 abid:7
    v_rcp_f32 v116, v116
    v_mfma_f32_4x4x4_16b_bf16 v[84:87], v[88:89], v[78:79], 0 cbsz:4 abid:7
    v_rcp_f32 v117, v117
    buffer_load_dwordx4 v[76:79], v[62:63], s[12:15], 0 idxen offen
    ds_read_b32 v62, v5 offset:60
    v_rcp_f32 v118, v118
    v_rcp_f32 v119, v119
    s_set_gpr_idx_on s32, gpr_idx(SRC2,DST)
    v_pk_fma_f32 v[8:9], v[80:81], v[122:123], v[8:9] op_sel:[0,1,0] op_sel_hi:[1,1,1]
    v_pk_fma_f32 v[10:11], v[82:83], v[122:123], v[10:11] op_sel:[0,1,0] op_sel_hi:[1,1,1]
    v_pk_fma_f32 v[12:13], v[84:85], v[126:127], v[12:13] op_sel:[0,1,0] op_sel_hi:[1,1,1]
    v_pk_fma_f32 v[14:15], v[86:87], v[126:127], v[14:15] op_sel:[0,1,0] op_sel_hi:[1,1,1]
    s_set_gpr_idx_off
    v_pk_mul_f32 v[120:121], v[96:97], v[112:113]
    v_pk_mul_f32 v[122:123], v[98:99], v[114:115]
    s_add_u32 s34, s34, 1
    s_cbranch_scc1 K2_MAIN_DONE
    s_waitcnt lgkmcnt(0)
    v_readfirstlane_b32 s32, v7
    s_cmp_ge_i32 s34, s46
    s_cbranch_scc1 K2_PR2
K2_PRR2:
    ds_read_b32 v7, v6 offset:10252
    s_waitcnt vmcnt(3)
    v_mfma_f32_4x4x4_16b_bf16 v[80:83], v[88:89], v[64:65], 0 cbsz:4 abid:8
    v_exp_f32 v112, v104
    v_mfma_f32_4x4x4_16b_bf16 v[84:87], v[88:89], v[66:67], 0 cbsz:4 abid:8
    v_exp_f32 v113, v105
    buffer_load_dwordx4 v[64:67], v[56:57], s[12:15], 0 idxen offen
    ds_read_b32 v56, v5 offset:64
    v_mfma_f32_4x4x4_16b_bf16 v[96:99], v[94:95], v[48:49], 0 cbsz:4 abid:0
    v_exp_f32 v114, v106
    v_exp_f32 v115, v107
    v_pk_mul_f32 v[124:125], v[100:101], v[116:117]
    v_pk_mul_f32 v[126:127], v[102:103], v[118:119]
    s_set_gpr_idx_on s32, gpr_idx(SRC2,DST)
    v_pk_fma_f32 v[8:9], v[80:81], v[120:121], v[8:9] op_sel_hi:[1,0,1]
    v_pk_fma_f32 v[10:11], v[82:83], v[120:121], v[10:11] op_sel_hi:[1,0,1]
    v_pk_fma_f32 v[12:13], v[84:85], v[124:125], v[12:13] op_sel_hi:[1,0,1]
    v_pk_fma_f32 v[14:15], v[86:87], v[124:125], v[14:15] op_sel_hi:[1,0,1]
    s_set_gpr_idx_off
    s_lshr_b32 s32, s32, 8
    s_waitcnt vmcnt(3)
    v_mfma_f32_4x4x4_16b_bf16 v[80:83], v[88:89], v[68:69], 0 cbsz:4 abid:9
    v_exp_f32 v116, v108
    v_mfma_f32_4x4x4_16b_bf16 v[84:87], v[88:89], v[70:71], 0 cbsz:4 abid:9
    v_exp_f32 v117, v109
    buffer_load_dwordx4 v[68:71], v[58:59], s[12:15], 0 idxen offen
    ds_read_b32 v58, v5 offset:68
    v_mfma_f32_4x4x4_16b_bf16 v[100:103], v[94:95], v[50:51], 0 cbsz:4 abid:0
    v_exp_f32 v118, v110
    v_exp_f32 v119, v111
    v_pk_add_f32 v[112:113], v[112:113], 1.0 op_sel_hi:[1,0]
    v_pk_add_f32 v[114:115], v[114:115], 1.0 op_sel_hi:[1,0]
    s_set_gpr_idx_on s32, gpr_idx(SRC2,DST)
    v_pk_fma_f32 v[8:9], v[80:81], v[120:121], v[8:9] op_sel:[0,1,0] op_sel_hi:[1,1,1]
    v_pk_fma_f32 v[10:11], v[82:83], v[120:121], v[10:11] op_sel:[0,1,0] op_sel_hi:[1,1,1]
    v_pk_fma_f32 v[12:13], v[84:85], v[124:125], v[12:13] op_sel:[0,1,0] op_sel_hi:[1,1,1]
    v_pk_fma_f32 v[14:15], v[86:87], v[124:125], v[14:15] op_sel:[0,1,0] op_sel_hi:[1,1,1]
    s_set_gpr_idx_off
    s_lshr_b32 s32, s32, 8
    s_waitcnt vmcnt(3)
    v_mfma_f32_4x4x4_16b_bf16 v[80:83], v[88:89], v[72:73], 0 cbsz:4 abid:10
    v_rcp_f32 v112, v112
    v_mfma_f32_4x4x4_16b_bf16 v[84:87], v[88:89], v[74:75], 0 cbsz:4 abid:10
    v_rcp_f32 v113, v113
    buffer_load_dwordx4 v[72:75], v[60:61], s[12:15], 0 idxen offen
    ds_read_b32 v60, v5 offset:72
    v_rcp_f32 v114, v114
    v_rcp_f32 v115, v115
    v_pk_add_f32 v[116:117], v[116:117], 1.0 op_sel_hi:[1,0]
    v_pk_add_f32 v[118:119], v[118:119], 1.0 op_sel_hi:[1,0]
    s_set_gpr_idx_on s32, gpr_idx(SRC2,DST)
    v_pk_fma_f32 v[8:9], v[80:81], v[122:123], v[8:9] op_sel_hi:[1,0,1]
    v_pk_fma_f32 v[10:11], v[82:83], v[122:123], v[10:11] op_sel_hi:[1,0,1]
    v_pk_fma_f32 v[12:13], v[84:85], v[126:127], v[12:13] op_sel_hi:[1,0,1]
    v_pk_fma_f32 v[14:15], v[86:87], v[126:127], v[14:15] op_sel_hi:[1,0,1]
    s_set_gpr_idx_off
    s_lshr_b32 s32, s32, 8
    s_waitcnt vmcnt(3)
    v_mfma_f32_4x4x4_16b_bf16 v[80:83], v[88:89], v[76:77], 0 cbsz:4 abid:11
    v_rcp_f32 v116, v116
    v_mfma_f32_4x4x4_16b_bf16 v[84:87], v[88:89], v[78:79], 0 cbsz:4 abid:11
    v_rcp_f32 v117, v117
    buffer_load_dwordx4 v[76:79], v[62:63], s[12:15], 0 idxen offen
    ds_read_b32 v62, v5 offset:76
    v_rcp_f32 v118, v118
    v_rcp_f32 v119, v119
    s_set_gpr_idx_on s32, gpr_idx(SRC2,DST)
    v_pk_fma_f32 v[8:9], v[80:81], v[122:123], v[8:9] op_sel:[0,1,0] op_sel_hi:[1,1,1]
    v_pk_fma_f32 v[10:11], v[82:83], v[122:123], v[10:11] op_sel:[0,1,0] op_sel_hi:[1,1,1]
    v_pk_fma_f32 v[12:13], v[84:85], v[126:127], v[12:13] op_sel:[0,1,0] op_sel_hi:[1,1,1]
    v_pk_fma_f32 v[14:15], v[86:87], v[126:127], v[14:15] op_sel:[0,1,0] op_sel_hi:[1,1,1]
    s_set_gpr_idx_off
    v_pk_mul_f32 v[120:121], v[104:105], v[112:113]
    v_pk_mul_f32 v[122:123], v[106:107], v[114:115]
    s_add_u32 s34, s34, 1
    s_cbranch_scc1 K2_MAIN_DONE
    s_waitcnt lgkmcnt(0)
    v_readfirstlane_b32 s32, v7
    s_cmp_ge_i32 s34, s46
    s_cbranch_scc1 K2_PR3
K2_PRR3:
    ds_read_b32 v7, v6 offset:10256
    s_waitcnt vmcnt(3)
    v_mfma_f32_4x4x4_16b_bf16 v[80:83], v[88:89], v[64:65], 0 cbsz:4 abid:12
    v_exp_f32 v112, v96
    v_mfma_f32_4x4x4_16b_bf16 v[84:87], v[88:89], v[66:67], 0 cbsz:4 abid:12
    v_exp_f32 v113, v97
    buffer_load_dwordx4 v[64:67], v[56:57], s[12:15], 0 idxen offen
    ds_read_b32 v56, v5 offset:80
    v_mfma_f32_4x4x4_16b_bf16 v[104:107], v[94:95], v[48:49], 0 cbsz:4 abid:1
    v_exp_f32 v114, v98
    v_exp_f32 v115, v99
    v_pk_mul_f32 v[124:125], v[108:109], v[116:117]
    v_pk_mul_f32 v[126:127], v[110:111], v[118:119]
    s_set_gpr_idx_on s32, gpr_idx(SRC2,DST)
    v_pk_fma_f32 v[8:9], v[80:81], v[120:121], v[8:9] op_sel_hi:[1,0,1]
    v_pk_fma_f32 v[10:11], v[82:83], v[120:121], v[10:11] op_sel_hi:[1,0,1]
    v_pk_fma_f32 v[12:13], v[84:85], v[124:125], v[12:13] op_sel_hi:[1,0,1]
    v_pk_fma_f32 v[14:15], v[86:87], v[124:125], v[14:15] op_sel_hi:[1,0,1]
    s_set_gpr_idx_off
    s_lshr_b32 s32, s32, 8
    s_waitcnt vmcnt(3)
    v_mfma_f32_4x4x4_16b_bf16 v[80:83], v[88:89], v[68:69], 0 cbsz:4 abid:13
    v_exp_f32 v116, v100
    v_mfma_f32_4x4x4_16b_bf16 v[84:87], v[88:89], v[70:71], 0 cbsz:4 abid:13
    v_exp_f32 v117, v101
    buffer_load_dwordx4 v[68:71], v[58:59], s[12:15], 0 idxen offen
    ds_read_b32 v58, v5 offset:84
    v_mfma_f32_4x4x4_16b_bf16 v[108:111], v[94:95], v[50:51], 0 cbsz:4 abid:1
    v_exp_f32 v118, v102
    v_exp_f32 v119, v103
    v_pk_add_f32 v[112:113], v[112:113], 1.0 op_sel_hi:[1,0]
    v_pk_add_f32 v[114:115], v[114:115], 1.0 op_sel_hi:[1,0]
    s_set_gpr_idx_on s32, gpr_idx(SRC2,DST)
    v_pk_fma_f32 v[8:9], v[80:81], v[120:121], v[8:9] op_sel:[0,1,0] op_sel_hi:[1,1,1]
    v_pk_fma_f32 v[10:11], v[82:83], v[120:121], v[10:11] op_sel:[0,1,0] op_sel_hi:[1,1,1]
    v_pk_fma_f32 v[12:13], v[84:85], v[124:125], v[12:13] op_sel:[0,1,0] op_sel_hi:[1,1,1]
    v_pk_fma_f32 v[14:15], v[86:87], v[124:125], v[14:15] op_sel:[0,1,0] op_sel_hi:[1,1,1]
    s_set_gpr_idx_off
    s_lshr_b32 s32, s32, 8
    s_waitcnt vmcnt(3)
    v_mfma_f32_4x4x4_16b_bf16 v[80:83], v[88:89], v[72:73], 0 cbsz:4 abid:14
    v_rcp_f32 v112, v112
    v_mfma_f32_4x4x4_16b_bf16 v[84:87], v[88:89], v[74:75], 0 cbsz:4 abid:14
    v_rcp_f32 v113, v113
    buffer_load_dwordx4 v[72:75], v[60:61], s[12:15], 0 idxen offen
    ds_read_b32 v60, v5 offset:88
    v_rcp_f32 v114, v114
    v_rcp_f32 v115, v115
    v_pk_add_f32 v[116:117], v[116:117], 1.0 op_sel_hi:[1,0]
    v_pk_add_f32 v[118:119], v[118:119], 1.0 op_sel_hi:[1,0]
    s_set_gpr_idx_on s32, gpr_idx(SRC2,DST)
    v_pk_fma_f32 v[8:9], v[80:81], v[122:123], v[8:9] op_sel_hi:[1,0,1]
    v_pk_fma_f32 v[10:11], v[82:83], v[122:123], v[10:11] op_sel_hi:[1,0,1]
    v_pk_fma_f32 v[12:13], v[84:85], v[126:127], v[12:13] op_sel_hi:[1,0,1]
    v_pk_fma_f32 v[14:15], v[86:87], v[126:127], v[14:15] op_sel_hi:[1,0,1]
    s_set_gpr_idx_off
    s_lshr_b32 s32, s32, 8
    s_waitcnt vmcnt(3)
    v_mfma_f32_4x4x4_16b_bf16 v[80:83], v[88:89], v[76:77], 0 cbsz:4 abid:15
    v_rcp_f32 v116, v116
    v_mfma_f32_4x4x4_16b_bf16 v[84:87], v[88:89], v[78:79], 0 cbsz:4 abid:15
    v_rcp_f32 v117, v117
    buffer_load_dwordx4 v[76:79], v[62:63], s[12:15], 0 idxen offen
    ds_read_b32 v62, v5 offset:92
    v_rcp_f32 v118, v118
    v_rcp_f32 v119, v119
    s_set_gpr_idx_on s32, gpr_idx(SRC2,DST)
    v_pk_fma_f32 v[8:9], v[80:81], v[122:123], v[8:9] op_sel:[0,1,0] op_sel_hi:[1,1,1]
    v_pk_fma_f32 v[10:11], v[82:83], v[122:123], v[10:11] op_sel:[0,1,0] op_sel_hi:[1,1,1]
    v_pk_fma_f32 v[12:13], v[84:85], v[126:127], v[12:13] op_sel:[0,1,0] op_sel_hi:[1,1,1]
    v_pk_fma_f32 v[14:15], v[86:87], v[126:127], v[14:15] op_sel:[0,1,0] op_sel_hi:[1,1,1]
    s_set_gpr_idx_off
    v_pk_mul_f32 v[120:121], v[96:97], v[112:113]
    v_pk_mul_f32 v[122:123], v[98:99], v[114:115]
    s_add_u32 s34, s34, 1
    s_cbranch_scc1 K2_MAIN_DONE
    v_mov_b32 v88, v90
    v_mov_b32 v89, v91
    v_mov_b32 v92, v94
    v_mov_b32 v93, v95
    v_add_u32 v3, 256, v3
    v_add_u32 v4, 128, v4
    v_add_u32 v5, 64, v5
    v_add_u32 v6, 16, v6
    s_branch K2_LOOP
K2_PR0:
    s_cmp_eq_u32 s43, 2
    s_cbranch_scc0 K2_PRA0
    s_setprio 2
    s_mov_b32 s43, 1
    s_mov_b32 s46, s69
    s_branch K2_PRR0
K2_PRA0:
    s_cmp_eq_u32 s43, 1
    s_cbranch_scc0 K2_PRB0
    s_setprio 1
    s_mov_b32 s43, 0
    s_mov_b32 s46, s70
    s_branch K2_PRR0
K2_PRB0:
    s_setprio 0
    s_mov_b32 s46, 0x7fffffff
    s_branch K2_PRR0
K2_PR1:
    s_cmp_eq_u32 s43, 2
    s_cbranch_scc0 K2_PRA1
    s_setprio 2
    s_mov_b32 s43, 1
    s_mov_b32 s46, s69
    s_branch K2_PRR1
K2_PRA1:
    s_cmp_eq_u32 s43, 1
    s_cbranch_scc0 K2_PRB1
    s_setprio 1
    s_mov_b32 s43, 0
    s_mov_b32 s46, s70
    s_branch K2_PRR1
K2_PRB1:
    s_setprio 0
    s_mov_b32 s46, 0x7fffffff
    s_branch K2_PRR1
K2_PR2:
    s_cmp_eq_u32 s43, 2
    s_cbranch_scc0 K2_PRA2
    s_setprio 2
    s_mov_b32 s43, 1
    s_mov_b32 s46, s69
    s_branch K2_PRR2
K2_PRA2:
    s_cmp_eq_u32 s43, 1
    s_cbranch_scc0 K2_PRB2
    s_setprio 1
    s_mov_b32 s43, 0
    s_mov_b32 s46, s70
    s_branch K2_PRR2
K2_PRB2:
    s_setprio 0
    s_mov_b32 s46, 0x7fffffff
    s_branch K2_PRR2
K2_PR3:
    s_cmp_eq_u32 s43, 2
    s_cbranch_scc0 K2_PRA3
    s_setprio 2
    s_mov_b32 s43, 1
    s_mov_b32 s46, s69
    s_branch K2_PRR3
K2_PRA3:
    s_cmp_eq_u32 s43, 1
    s_cbranch_scc0 K2_PRB3
    s_setprio 1
    s_mov_b32 s43, 0
    s_mov_b32 s46, s70
    s_branch K2_PRR3
K2_PRB3:
    s_setprio 0
    s_mov_b32 s46, 0x7fffffff
    s_branch K2_PRR3
K2_MAIN_DONE:
    s_setprio 0
    s_add_u32 s19, s19, s20
    s_cmp_lt_u32 s19, s18
    s_cbranch_scc0 K2_EPI
    s_waitcnt vmcnt(0) lgkmcnt(0)
    s_branch K2_ROUND
K2_EPI:
    s_waitcnt lgkmcnt(0)
    s_and_b32 s47, s16, 3
    s_lshr_b32 s46, s16, 2
    s_lshl_b32 s36, s47, 13
    s_add_u32 s36, s36, 4096
    v_add_u32 v2, s36, v57
    v_add_u32 v3, 4096, v2
    global_load_dwordx4 v[96:99], v2, s[58:59] offset:0 sc1
    global_load_dwordx4 v[100:103], v2, s[58:59] offset:1024 sc1
    global_load_dwordx4 v[104:107], v2, s[58:59] offset:2048 sc1
    global_load_dwordx4 v[108:111], v2, s[58:59] offset:3072 sc1
    global_load_dwordx4 v[112:115], v3, s[58:59] offset:0 sc1
    global_load_dwordx4 v[116:119], v3, s[58:59] offset:1024 sc1
    global_load_dwordx4 v[120:123], v3, s[58:59] offset:2048 sc1
    global_load_dwordx4 v[124:127], v3, s[58:59] offset:3072 sc1
    s_mul_i32 s36, s16, 5248
    s_add_u32 s36, s36, 47744
    s_xor_b32 s37, s16, 1
    s_mul_i32 s37, s37, 5248
    s_add_u32 s37, s37, 47744
    v_lshlrev_b32 v4, 3, v1
    v_add_u32 v5, s36, v4
    v_add_u32 v6, 2048, v5
    v_add_u32 v7, 4096, v5
    s_cmp_eq_u32 s23, 0
    s_cbranch_scc0 K2_EXW1
    ds_write2_b64 v5, v[10:11], v[14:15] offset0:0 offset1:64
    ds_write2_b64 v5, v[18:19], v[22:23] offset0:128 offset1:192
    ds_write2_b64 v6, v[26:27], v[30:31] offset0:0 offset1:64
    ds_write2_b64 v6, v[34:35], v[38:39] offset0:128 offset1:192
    ds_write2_b64 v7, v[42:43], v[46:47] offset0:0 offset1:64
    s_branch K2_EXW2
K2_EXW1:
    ds_write2_b64 v5, v[8:9], v[12:13] offset0:0 offset1:64
    ds_write2_b64 v5, v[16:17], v[20:21] offset0:128 offset1:192
    ds_write2_b64 v6, v[24:25], v[28:29] offset0:0 offset1:64
    ds_write2_b64 v6, v[32:33], v[36:37] offset0:128 offset1:192
    ds_write2_b64 v7, v[40:41], v[44:45] offset0:0 offset1:64
K2_EXW2:
    v_add_u32 v56, s37, v4
    v_add_u32 v58, 2048, v56
    v_add_u32 v60, 4096, v56
    s_mul_i32 s38, s28, 20
    s_lshl_b32 s39, s23, 1
    s_add_u32 s38, s38, s39
    s_mul_i32 s38, s38, 272
    v_lshlrev_b32 v4, 2, v1
    v_add_u32 v62, s38, v4
    s_mul_i32 s36, s46, 3
    s_lshl_b32 s37, s46, 1
    s_add_u32 s37, s37, 2
    s_cmp_lt_u32 s46, 2
    s_cselect_b32 s36, s36, s37
    s_mul_i32 s37, s36, 4352
    v_and_b32 v3, 15, v1
    v_lshrrev_b32 v4, 4, v1
    v_mul_u32_u24 v7, 272, v3
    v_lshl_add_u32 v7, v4, 4, v7
    v_add_u32 v57, s37, v7
    v_lshlrev_b32 v3, 4, v3
    v_lshl_add_u32 v59, v4, 10, v3
    s_lshl_b32 s36, s36, 2
    s_mul_i32 s37, s17, 40
    s_add_u32 s37, s37, s36
    s_lshl_b32 s37, s37, 10
    s_lshl_b32 s38, s47, 8
    s_add_u32 s37, s37, s38
    s_add_u32 s6, s6, s37
    s_addc_u32 s7, s7, 0
    s_waitcnt vmcnt(8) lgkmcnt(0)
    s_barrier
    ds_read2_b64 v[64:67], v56 offset0:0 offset1:64
    ds_read2_b64 v[68:71], v56 offset0:128 offset1:192
    ds_read2_b64 v[72:75], v58 offset0:0 offset1:64
    ds_read2_b64 v[76:79], v58 offset0:128 offset1:192
    ds_read2_b64 v[80:83], v60 offset0:0 offset1:64
    s_cmp_eq_u32 s23, 0
    s_cbranch_scc0 K2_CB1
    s_waitcnt lgkmcnt(4)
    v_pk_add_f32 v[8:9], v[8:9], v[64:65]
    v_pk_add_f32 v[12:13], v[12:13], v[66:67]
    v_pk_mul_f32 v[8:9], v[8:9], s[44:45]
    v_pk_mul_f32 v[12:13], v[12:13], s[44:45]
    v_cvt_pk_bf16_f32 v2, v8, v12
    v_cvt_pk_bf16_f32 v3, v9, v13
    ds_write_b32 v62, v2 offset:0
    ds_write_b32 v62, v3 offset:272
    s_waitcnt lgkmcnt(5)
    v_pk_add_f32 v[16:17], v[16:17], v[68:69]
    v_pk_add_f32 v[20:21], v[20:21], v[70:71]
    v_pk_mul_f32 v[16:17], v[16:17], s[44:45]
    v_pk_mul_f32 v[20:21], v[20:21], s[44:45]
    v_cvt_pk_bf16_f32 v4, v16, v20
    v_cvt_pk_bf16_f32 v5, v17, v21
    ds_write_b32 v62, v4 offset:1088
    ds_write_b32 v62, v5 offset:1360
    s_waitcnt lgkmcnt(6)
    v_pk_add_f32 v[24:25], v[24:25], v[72:73]
    v_pk_add_f32 v[28:29], v[28:29], v[74:75]
    v_pk_mul_f32 v[24:25], v[24:25], s[44:45]
    v_pk_mul_f32 v[28:29], v[28:29], s[44:45]
    v_cvt_pk_bf16_f32 v2, v24, v28
    v_cvt_pk_bf16_f32 v3, v25, v29
    ds_write_b32 v62, v2 offset:2176
    ds_write_b32 v62, v3 offset:2448
    s_waitcnt lgkmcnt(7)
    v_pk_add_f32 v[32:33], v[32:33], v[76:77]
    v_pk_add_f32 v[36:37], v[36:37], v[78:79]
    v_pk_mul_f32 v[32:33], v[32:33], s[44:45]
    v_pk_mul_f32 v[36:37], v[36:37], s[44:45]
    v_cvt_pk_bf16_f32 v4, v32, v36
    v_cvt_pk_bf16_f32 v5, v33, v37
    ds_write_b32 v62, v4 offset:3264
    ds_write_b32 v62, v5 offset:3536
    s_waitcnt lgkmcnt(8)
    v_pk_add_f32 v[40:41], v[40:41], v[80:81]
    v_pk_add_f32 v[44:45], v[44:45], v[82:83]
    v_pk_mul_f32 v[40:41], v[40:41], s[44:45]
    v_pk_mul_f32 v[44:45], v[44:45], s[44:45]
    v_cvt_pk_bf16_f32 v2, v40, v44
    v_cvt_pk_bf16_f32 v3, v41, v45
    ds_write_b32 v62, v2 offset:4352
    ds_write_b32 v62, v3 offset:4624
    s_branch K2_CB2
K2_CB1:
    s_waitcnt lgkmcnt(4)
    v_pk_add_f32 v[10:11], v[10:11], v[64:65]
    v_pk_add_f32 v[14:15], v[14:15], v[66:67]
    v_pk_mul_f32 v[10:11], v[10:11], s[44:45]
    v_pk_mul_f32 v[14:15], v[14:15], s[44:45]
    v_cvt_pk_bf16_f32 v2, v10, v14
    v_cvt_pk_bf16_f32 v3, v11, v15
    ds_write_b32 v62, v2 offset:0
    ds_write_b32 v62, v3 offset:272
    s_waitcnt lgkmcnt(5)
    v_pk_add_f32 v[18:19], v[18:19], v[68:69]
    v_pk_add_f32 v[22:23], v[22:23], v[70:71]
    v_pk_mul_f32 v[18:19], v[18:19], s[44:45]
    v_pk_mul_f32 v[22:23], v[22:23], s[44:45]
    v_cvt_pk_bf16_f32 v4, v18, v22
    v_cvt_pk_bf16_f32 v5, v19, v23
    ds_write_b32 v62, v4 offset:1088
    ds_write_b32 v62, v5 offset:1360
    s_waitcnt lgkmcnt(6)
    v_pk_add_f32 v[26:27], v[26:27], v[72:73]
    v_pk_add_f32 v[30:31], v[30:31], v[74:75]
    v_pk_mul_f32 v[26:27], v[26:27], s[44:45]
    v_pk_mul_f32 v[30:31], v[30:31], s[44:45]
    v_cvt_pk_bf16_f32 v2, v26, v30
    v_cvt_pk_bf16_f32 v3, v27, v31
    ds_write_b32 v62, v2 offset:2176
    ds_write_b32 v62, v3 offset:2448
    s_waitcnt lgkmcnt(7)
    v_pk_add_f32 v[34:35], v[34:35], v[76:77]
    v_pk_add_f32 v[38:39], v[38:39], v[78:79]
    v_pk_mul_f32 v[34:35], v[34:35], s[44:45]
    v_pk_mul_f32 v[38:39], v[38:39], s[44:45]
    v_cvt_pk_bf16_f32 v4, v34, v38
    v_cvt_pk_bf16_f32 v5, v35, v39
    ds_write_b32 v62, v4 offset:3264
    ds_write_b32 v62, v5 offset:3536
    s_waitcnt lgkmcnt(8)
    v_pk_add_f32 v[42:43], v[42:43], v[80:81]
    v_pk_add_f32 v[46:47], v[46:47], v[82:83]
    v_pk_mul_f32 v[42:43], v[42:43], s[44:45]
    v_pk_mul_f32 v[46:47], v[46:47], s[44:45]
    v_cvt_pk_bf16_f32 v2, v42, v46
    v_cvt_pk_bf16_f32 v3, v43, v47
    ds_write_b32 v62, v2 offset:4352
    ds_write_b32 v62, v3 offset:4624
K2_CB2:
    s_waitcnt lgkmcnt(0)
    s_barrier
    ds_read_b128 v[64:67], v57 offset:0
    ds_read_b128 v[68:71], v57 offset:64
    ds_read_b128 v[72:75], v57 offset:128
    ds_read_b128 v[76:79], v57 offset:192
    ds_read_b128 v[80:83], v57 offset:4352
    ds_read_b128 v[84:87], v57 offset:4416
    ds_read_b128 v[88:91], v57 offset:4480
    ds_read_b128 v[92:95], v57 offset:4544
    s_waitcnt vmcnt(0) lgkmcnt(4)
    v_mfma_f32_16x16x32_bf16 v[8:11], v[64:67], v[96:99], 0
    v_mfma_f32_16x16x32_bf16 v[12:15], v[64:67], v[112:115], 0
    v_mfma_f32_16x16x32_bf16 v[8:11], v[68:71], v[100:103], v[8:11]
    v_mfma_f32_16x16x32_bf16 v[12:15], v[68:71], v[116:119], v[12:15]
    v_mfma_f32_16x16x32_bf16 v[8:11], v[72:75], v[104:107], v[8:11]
    v_mfma_f32_16x16x32_bf16 v[12:15], v[72:75], v[120:123], v[12:15]
    v_mfma_f32_16x16x32_bf16 v[8:11], v[76:79], v[108:111], v[8:11]
    v_mfma_f32_16x16x32_bf16 v[12:15], v[76:79], v[124:127], v[12:15]
    s_cmp_lt_u32 s46, 2
    s_cbranch_scc0 K2_MIX2
    ds_read_b128 v[64:67], v57 offset:8704
    ds_read_b128 v[68:71], v57 offset:8768
    ds_read_b128 v[72:75], v57 offset:8832
    ds_read_b128 v[76:79], v57 offset:8896
    s_waitcnt lgkmcnt(4)
    v_mfma_f32_16x16x32_bf16 v[16:19], v[80:83], v[96:99], 0
    v_mfma_f32_16x16x32_bf16 v[20:23], v[80:83], v[112:115], 0
    v_mfma_f32_16x16x32_bf16 v[16:19], v[84:87], v[100:103], v[16:19]
    v_mfma_f32_16x16x32_bf16 v[20:23], v[84:87], v[116:119], v[20:23]
    v_mfma_f32_16x16x32_bf16 v[16:19], v[88:91], v[104:107], v[16:19]
    v_mfma_f32_16x16x32_bf16 v[20:23], v[88:91], v[120:123], v[20:23]
    v_mfma_f32_16x16x32_bf16 v[16:19], v[92:95], v[108:111], v[16:19]
    v_mfma_f32_16x16x32_bf16 v[20:23], v[92:95], v[124:127], v[20:23]
    v_cvt_pk_bf16_f32 v32, v8, v9
    v_cvt_pk_bf16_f32 v33, v10, v11
    v_cvt_pk_bf16_f32 v34, v12, v13
    v_cvt_pk_bf16_f32 v35, v14, v15
    global_store_dwordx4 v59, v[32:35], s[6:7] sc1
    s_waitcnt lgkmcnt(0)
    v_mfma_f32_16x16x32_bf16 v[24:27], v[64:67], v[96:99], 0
    v_mfma_f32_16x16x32_bf16 v[28:31], v[64:67], v[112:115], 0
    v_mfma_f32_16x16x32_bf16 v[24:27], v[68:71], v[100:103], v[24:27]
    v_mfma_f32_16x16x32_bf16 v[28:31], v[68:71], v[116:119], v[28:31]
    v_mfma_f32_16x16x32_bf16 v[24:27], v[72:75], v[104:107], v[24:27]
    v_mfma_f32_16x16x32_bf16 v[28:31], v[72:75], v[120:123], v[28:31]
    v_mfma_f32_16x16x32_bf16 v[24:27], v[76:79], v[108:111], v[24:27]
    v_mfma_f32_16x16x32_bf16 v[28:31], v[76:79], v[124:127], v[28:31]
    v_cvt_pk_bf16_f32 v36, v16, v17
    v_cvt_pk_bf16_f32 v37, v18, v19
    v_cvt_pk_bf16_f32 v38, v20, v21
    v_cvt_pk_bf16_f32 v39, v22, v23
    v_add_u32 v59, 4096, v59
    global_store_dwordx4 v59, v[36:39], s[6:7] sc1
    s_nop 4
    v_cvt_pk_bf16_f32 v40, v24, v25
    v_cvt_pk_bf16_f32 v41, v26, v27
    v_cvt_pk_bf16_f32 v42, v28, v29
    v_cvt_pk_bf16_f32 v43, v30, v31
    v_add_u32 v59, 4096, v59
    global_store_dwordx4 v59, v[40:43], s[6:7] sc1
    s_branch K2_MIXD
K2_MIX2:
    s_waitcnt lgkmcnt(0)
    v_mfma_f32_16x16x32_bf16 v[16:19], v[80:83], v[96:99], 0
    v_mfma_f32_16x16x32_bf16 v[20:23], v[80:83], v[112:115], 0
    v_mfma_f32_16x16x32_bf16 v[16:19], v[84:87], v[100:103], v[16:19]
    v_mfma_f32_16x16x32_bf16 v[20:23], v[84:87], v[116:119], v[20:23]
    v_mfma_f32_16x16x32_bf16 v[16:19], v[88:91], v[104:107], v[16:19]
    v_mfma_f32_16x16x32_bf16 v[20:23], v[88:91], v[120:123], v[20:23]
    v_mfma_f32_16x16x32_bf16 v[16:19], v[92:95], v[108:111], v[16:19]
    v_mfma_f32_16x16x32_bf16 v[20:23], v[92:95], v[124:127], v[20:23]
    v_cvt_pk_bf16_f32 v32, v8, v9
    v_cvt_pk_bf16_f32 v33, v10, v11
    v_cvt_pk_bf16_f32 v34, v12, v13
    v_cvt_pk_bf16_f32 v35, v14, v15
    global_store_dwordx4 v59, v[32:35], s[6:7] sc1
    s_nop 4
    v_cvt_pk_bf16_f32 v36, v16, v17
    v_cvt_pk_bf16_f32 v37, v18, v19
    v_cvt_pk_bf16_f32 v38, v20, v21
    v_cvt_pk_bf16_f32 v39, v22, v23
    v_add_u32 v59, 4096, v59
    global_store_dwordx4 v59, v[36:39], s[6:7] sc1
K2_MIXD:
K2_END:
    s_endpgm
K2_CODE_END:
.section .rodata,"a"
.p2align 6
.amdhsa_kernel standalone__tensor_product_equiv_tfn__graph_kernel
  .amdhsa_next_free_vgpr 128
  .amdhsa_next_free_sgpr 80
  .amdhsa_accum_offset 128
  .amdhsa_group_segment_fixed_size 0
  .amdhsa_kernarg_size 88
  .amdhsa_user_sgpr_count 2
  .amdhsa_user_sgpr_kernarg_segment_ptr 1
  .amdhsa_system_sgpr_workgroup_id_x 1
  .amdhsa_float_denorm_mode_32 3
.end_amdhsa_kernel
```
